```python
import torch

def _softmax(x, axis=-1):
    return torch.softmax(x, dim=axis)
def _gelu(x):
    return torch.nn.functional.gelu(x, approximate="tanh")
def _silu(x):
    return torch.nn.functional.silu(x)
def _sigmoid(x):
    return torch.sigmoid(x)
def _layernorm(x, axis=-1, eps=1e-5):
    m = x.mean(dim=axis, keepdim=True)
    v = x.var(dim=axis, keepdim=True, unbiased=False)
    return (x - m) / torch.sqrt(v + eps)
def _scatter_add(tgt, idx, src, axis=0):
    return tgt.clone().index_add_(axis, idx, src)
def _segment_sum(src, seg, n):
    out = torch.zeros((n,) + src.shape[1:], dtype=src.dtype)
    return out.index_add_(0, seg, src)
def _pad(x, pw):
    flat = tuple(v for pair in reversed(pw) for v in pair)
    return torch.nn.functional.pad(x, flat)

kernel_name = 'sequential_preLN__sliding_block_cached__glu_gated_bilinear__decode'

def setup_inputs():

    _w = (lambda a: (lambda t: t.to(torch.bfloat16) if t.is_floating_point() else t)(torch.as_tensor(a)))
    def _A_setup():
        B, Sq, D = 8, 1, 512
        Hq, Hkv, Sk, Dh = 32, 8, 8192, 128
        assert Hq % Hkv == 0, (Hq, Hkv)
        return {
            "x": _w((lambda *s: torch.randn(*s, dtype=torch.bfloat16) * 0.05)(B, Sq, D)),
            "k_cache": _w((lambda *s: torch.randn(*s, dtype=torch.bfloat16) * 1.6)(B, Hkv, Sk, Dh)),
            "v_cache": _w((lambda *s: torch.randn(*s, dtype=torch.bfloat16) * 0.8)(B, Hkv, Sk, Dh)),
            "wq": _w((lambda *s: torch.randn(*s, dtype=torch.bfloat16) * 1.6)(D, Hq * Dh) * (D ** -0.5)),
            "wo": _w((lambda *s: torch.randn(*s, dtype=torch.bfloat16) * 0.8)(Hq * Dh, D) * ((Hq * Dh) ** -0.5)),
        }
    _A_in = _A_setup()

    def _B_setup():
        B, S, D, F = 8, 1, 512, 1792
        return {
            "x": _w((lambda *s: torch.randn(*s, dtype=torch.bfloat16) * 0.05)(B, S, D)),
            "w_gate": _w((lambda *s: torch.randn(*s, dtype=torch.bfloat16) * 0.4)(D, F) * (D ** -0.5)),
            "w_up": _w((lambda *s: torch.randn(*s, dtype=torch.bfloat16) * 0.4)(D, F) * (D ** -0.5)),
            "w_down": _w((lambda *s: torch.randn(*s, dtype=torch.bfloat16) * 0.4)(F, D) * (F ** -0.5)),
        }
    _B_in = _B_setup()

    return {
        "A_x": _A_in["x"],
        "A_k_cache": _A_in["k_cache"],
        "A_v_cache": _A_in["v_cache"],
        "A_wq": _A_in["wq"],
        "A_wo": _A_in["wo"],
        "B_x": _B_in["x"],
        "B_w_gate": _B_in["w_gate"],
        "B_w_up": _B_in["w_up"],
        "B_w_down": _B_in["w_down"],
    }

def reference(A_x, A_k_cache, A_v_cache, A_wq, A_wo, B_x, B_w_gate, B_w_up, B_w_down):
    def _A_ref(x, k_cache, v_cache, wq, wo):
        B, Sq, D = x.shape
        Hq, Dh = 32, 128
        Hkv, Sk = k_cache.shape[1], k_cache.shape[2]
        W = min(4096, max(256, Sk // 4))
        rep = Hq // Hkv
        q = (lambda x, *d: x.permute(*d))((x @ wq).reshape(B, Sq, Hq, Dh), 0, 2, 1, 3)
        k = (lambda x, n, axis: torch.repeat_interleave(x, n, dim=axis))(k_cache[:, :, Sk - W:, :], rep, axis=1)
        v = (lambda x, n, axis: torch.repeat_interleave(x, n, dim=axis))(v_cache[:, :, Sk - W:, :], rep, axis=1)
        scores = torch.einsum("bhqd,bhkd->bhqk", q, k) * (Dh ** -0.5)
        p = _softmax(scores, axis=-1)
        o = torch.einsum("bhqk,bhkd->bhqd", p, v)
        return (lambda x, *d: x.permute(*d))(o, 0, 2, 1, 3).reshape(B, Sq, Hq * Dh) @ wo

    def _B_ref(x, w_gate, w_up, w_down):
        g = torch.einsum("bsd,df->bsf", x, w_gate)
        u = torch.einsum("bsd,df->bsf", x, w_up)
        h = g * u
        return torch.einsum("bsf,fd->bsd", h, w_down)

    x = A_x
    h = x + _A_ref(_layernorm(x, axis=-1), A_k_cache, A_v_cache, A_wq, A_wo)
    h2 = h + _B_ref(_layernorm(h, axis=-1), B_w_gate, B_w_up, B_w_down)
    return h2
```

```asm
; @launch grid=(256,1,1) block=(512,1,1) lds=78848
.amdgcn_target "amdgcn-amd-amdhsa--gfx950"
.text
.globl sequential_preLN__sliding_block_cached__glu_gated_bilinear__decode_kernel
.p2align 8
.type sequential_preLN__sliding_block_cached__glu_gated_bilinear__decode_kernel,@function
sequential_preLN__sliding_block_cached__glu_gated_bilinear__decode_kernel:
    s_cmp_ge_u32 s2, 256
    s_cbranch_scc1 L_end
    s_load_dwordx16 s[16:31], s[0:1], 0
    s_load_dwordx8 s[32:39], s[0:1], 64

    v_lshrrev_b32 v10, 6, v0
    s_lshr_b32 s4, s2, 3
    v_and_b32 v1, 63, v0
    v_readfirstlane_b32 s5, v10
    s_and_b32 s3, s2, 7
    s_lshr_b32 s6, s4, 2
    s_and_b32 s7, s4, 3

    s_getpc_b64 s[86:87]
L_pc:
    s_and_b32 s88, s4, 7
    s_lshl_b32 s88, s88, 11
    v_lshl_add_u32 v252, v0, 4, s88
    s_sub_u32 s86, s86, L_pc-sequential_preLN__sliding_block_cached__glu_gated_bilinear__decode_kernel
    s_subb_u32 s87, s87, 0
    v_min_u32 v252, L_codeend-sequential_preLN__sliding_block_cached__glu_gated_bilinear__decode_kernel-16, v252
    v_cmp_gt_u32 vcc, 128, v0
    s_and_saveexec_b64 s[88:89], vcc
    s_cbranch_execz L_nocpf
    global_load_dwordx4 v[244:247], v252, s[86:87]
L_nocpf:
    s_mov_b64 exec, -1

    v_lshlrev_b32 v8, 4, v1
    v_and_b32 v13, 127, v8
    v_lshrrev_b32 v12, 3, v1
    v_lshl_or_b32 v12, v12, 13, v13
    s_and_b32 s12, s4, 3
    s_lshl_b32 s12, s12, 20
    s_lshl_b32 s13, s5, 17
    s_or_b32 s12, s12, s13
    s_lshl_b32 s13, s3, 10
    s_or_b32 s12, s12, s13
    s_lshr_b32 s13, s4, 2
    s_lshl_b32 s13, s13, 7
    s_or_b32 s12, s12, s13

    s_lshl_b32 m0, s5, 11
    s_movk_i32 s54, 8192
    s_mov_b32 s55, 0x20000
    s_mov_b32 s58, 0x400000
    s_mov_b32 s59, s55
    s_lshl_b32 s15, s5, 10

    s_waitcnt lgkmcnt(0)
    s_mov_b64 s[56:57], s[22:23]
    s_mov_b64 s[52:53], s[16:17]
    buffer_load_dwordx4 v[192:195], v8, s[52:55], s15 offen
    buffer_load_dwordx4 v12, s[56:59], s12 offen nt lds
    s_add_u32 m0, m0, 1024
    s_add_u32 s12, s12, 65536
    buffer_load_dwordx4 v12, s[56:59], s12 offen nt lds
    v_and_b32 v10, 12, v1
    v_lshlrev_b32 v10, 6, v10
    v_and_b32 v11, 2, v1
    v_lshl_or_b32 v10, v11, 9, v10
    v_and_b32 v11, 1, v1
    v_lshl_or_b32 v10, v11, 6, v10
    v_and_or_b32 v9, v1, 48, v10
    s_lshl_b32 s10, s6, 24
    s_lshl_b32 s11, s3, 21
    s_or_b32 s10, s10, s11
    s_lshl_b32 s11, s7, 17
    s_or_b32 s10, s10, s11
    s_xor_b32 s11, s3, s5
    s_lshl_b32 s11, s11, 2
    s_xor_b32 s11, s11, s4
    s_lshl_b32 s11, s11, 12
    s_or_b32 s10, s10, s11
    s_or_b32 s60, s10, 1572864
    s_mov_b32 s42, 0x8000000
    s_mov_b32 s43, 0x20000

    s_mov_b64 s[40:41], s[18:19]
    s_barrier
    buffer_load_dwordx4 v[64:67], v9, s[40:43], s60 offen offset:0 nt
    buffer_load_dwordx4 v[68:71], v9, s[40:43], s60 offen offset:128 nt
    buffer_load_dwordx4 v[72:75], v9, s[40:43], s60 offen offset:2048 nt
    s_load_dword s8, s[38:39], 0
    s_xor_b32 s61, s60, 0x1000
    s_xor_b32 s62, s60, 0x2000
    s_xor_b32 s63, s60, 0x3000
    v_and_b32 v2, 15, v1
    v_lshrrev_b32 v3, 4, v1
    v_mov_b32 v56, 0
    v_lshlrev_b32 v58, 2, v2
    ds_write_b32 v58, v56 offset:17664

    s_mov_b32 s44, s20
    s_mov_b32 s45, s21
    s_mov_b32 s46, 0x8000000
    s_mov_b32 s47, 0x20000
    s_mov_b32 s48, s38
    s_mov_b32 s49, s39
    s_mov_b32 s50, 0x20000000
    s_mov_b32 s51, 0x20000
    s_mov_b32 s9, 0xff
    s_mov_b32 s74, 0xffff
    s_getreg_b32 s75, hwreg(HW_REG_XCC_ID, 0, 4)
    s_lshl_b32 s83, s3, 9
    s_add_u32 s83, s83, 630784
    v_mov_b32 v60, 0
    v_mov_b32 v57, 1
    s_cmp_ge_u32 s5, 8
    s_cselect_b32 s85, 3, 1
    s_bitcmp1_b32 s75, 0
    s_cselect_b32 s85, 0, s85

    s_waitcnt lgkmcnt(0)
    s_barrier
    s_add_u32 s8, s8, 0x9E3779B1
    s_and_b32 s10, s8, 0xff
    v_mov_b32 v4, s10
    s_bfe_u32 s10, s8, 0x80008
    v_mov_b32 v5, s10
    s_bfe_u32 s10, s8, 0x80010
    v_mov_b32 v6, s10
    s_lshr_b32 s10, s8, 24
    v_mov_b32 v7, s10

    s_waitcnt vmcnt(5)
    v_lshlrev_b32 v196, 16, v192
    v_and_b32 v197, 0xffff0000, v192
    v_lshlrev_b32 v198, 16, v193
    v_and_b32 v199, 0xffff0000, v193
    v_lshlrev_b32 v200, 16, v194
    v_and_b32 v201, 0xffff0000, v194
    v_lshlrev_b32 v202, 16, v195
    v_and_b32 v203, 0xffff0000, v195
    buffer_load_dwordx4 v[76:79], v9, s[40:43], s60 offen offset:2176 nt
    v_pk_add_f32 v[212:213], v[196:197], v[198:199]
    v_pk_add_f32 v[214:215], v[200:201], v[202:203]
    v_pk_mul_f32 v[216:217], v[196:197], v[196:197]
    v_pk_mul_f32 v[218:219], v[200:201], v[200:201]
    v_pk_add_f32 v[212:213], v[212:213], v[214:215]
    v_pk_fma_f32 v[216:217], v[198:199], v[198:199], v[216:217]
    v_pk_fma_f32 v[218:219], v[202:203], v[202:203], v[218:219]
    v_add_f32 v212, v212, v213
    v_pk_add_f32 v[216:217], v[216:217], v[218:219]
    v_add_f32 v213, v216, v217

    s_nop 0
    v_add_f32_dpp v212, v212, v212 quad_perm:[1,0,3,2] row_mask:0xf bank_mask:0xf
    v_add_f32_dpp v213, v213, v213 quad_perm:[1,0,3,2] row_mask:0xf bank_mask:0xf
    s_nop 0
    v_add_f32_dpp v212, v212, v212 quad_perm:[2,3,0,1] row_mask:0xf bank_mask:0xf
    v_add_f32_dpp v213, v213, v213 quad_perm:[2,3,0,1] row_mask:0xf bank_mask:0xf
    s_nop 0
    v_add_f32_dpp v212, v212, v212 row_half_mirror row_mask:0xf bank_mask:0xf
    v_add_f32_dpp v213, v213, v213 row_half_mirror row_mask:0xf bank_mask:0xf
    s_nop 0
    v_add_f32_dpp v212, v212, v212 row_ror:8 row_mask:0xf bank_mask:0xf
    v_add_f32_dpp v213, v213, v213 row_ror:8 row_mask:0xf bank_mask:0xf
    v_mov_b32 v214, 0x3b000000
    v_add_f32_dpp v212, v212, v212 row_bcast:15 row_mask:0xa bank_mask:0xf
    v_add_f32_dpp v213, v213, v213 row_bcast:15 row_mask:0xa bank_mask:0xf
    s_nop 0
    v_add_f32_dpp v212, v212, v212 row_bcast:31 row_mask:0xc bank_mask:0xf
    v_add_f32_dpp v213, v213, v213 row_bcast:31 row_mask:0xc bank_mask:0xf
    v_readlane_b32 s92, v212, 63
    v_readlane_b32 s93, v213, 63
    s_nop 0
    v_mul_f32 v212, s92, v214
    v_mul_f32 v213, s93, v214
    v_fma_f32 v213, -v212, v212, v213
    v_max_f32 v213, 0, v213
    v_cvt_pk_bf16_f32 v213, v212, v213
    v_lshlrev_b32 v214, 16, v213
    v_and_b32 v213, 0xffff0000, v213
    v_add_f32 v213, 0x3727c5ac, v213

    v_cvt_pk_bf16_f32 v213, v213, v213
    v_and_b32 v213, 0xffff0000, v213
    v_sqrt_f32 v213, v213
    v_pk_add_f32 v[196:197], v[196:197], v[214:215] op_sel_hi:[1,0] neg_lo:[0,1] neg_hi:[0,1]
    v_pk_add_f32 v[198:199], v[198:199], v[214:215] op_sel_hi:[1,0] neg_lo:[0,1] neg_hi:[0,1]
    v_pk_add_f32 v[200:201], v[200:201], v[214:215] op_sel_hi:[1,0] neg_lo:[0,1] neg_hi:[0,1]
    v_pk_add_f32 v[202:203], v[202:203], v[214:215] op_sel_hi:[1,0] neg_lo:[0,1] neg_hi:[0,1]
    v_cvt_pk_bf16_f32 v213, v213, v213
    v_and_b32 v213, 0xffff0000, v213
    v_rcp_f32 v216, v213
    v_cvt_pk_bf16_f32 v208, v196, v197
    v_cvt_pk_bf16_f32 v209, v198, v199
    v_cvt_pk_bf16_f32 v210, v200, v201
    v_cvt_pk_bf16_f32 v211, v202, v203
    v_lshlrev_b32 v196, 16, v208
    v_and_b32 v197, 0xffff0000, v208
    v_lshlrev_b32 v198, 16, v209
    v_and_b32 v199, 0xffff0000, v209
    v_lshlrev_b32 v200, 16, v210
    v_and_b32 v201, 0xffff0000, v210
    v_lshlrev_b32 v202, 16, v211
    v_and_b32 v203, 0xffff0000, v211
    v_pk_mul_f32 v[196:197], v[196:197], v[216:217] op_sel_hi:[1,0]
    v_pk_mul_f32 v[198:199], v[198:199], v[216:217] op_sel_hi:[1,0]
    v_pk_mul_f32 v[200:201], v[200:201], v[216:217] op_sel_hi:[1,0]
    v_pk_mul_f32 v[202:203], v[202:203], v[216:217] op_sel_hi:[1,0]
    v_cvt_pk_bf16_f32 v208, v196, v197
    v_cvt_pk_bf16_f32 v209, v198, v199
    v_cvt_pk_bf16_f32 v210, v200, v201
    v_cvt_pk_bf16_f32 v211, v202, v203
    s_mul_i32 s10, s5, 272
    v_lshl_add_u32 v14, v2, 4, s10
    v_cmp_eq_u32 vcc, s7, v3
    s_and_saveexec_b64 s[66:67], vcc
    ds_write_b128 v14, v[208:211] offset:18432
    s_mov_b64 exec, -1

    s_waitcnt vmcnt(4)
    s_mov_b64 exec, 1
    ds_add_u32 v56, v57 offset:17664
    s_mov_b64 exec, -1
    s_cmp_lg_u32 s5, 7
    s_cbranch_scc1 L_nosig
    s_lshl_b32 s84, s4, 4
    s_add_u32 s84, s84, s83
    v_mov_b32 v48, s75
    v_mov_b32 v49, 0
    v_mov_b32 v50, 0
    v_mov_b32 v51, s8
    s_mov_b64 exec, 1
    buffer_store_dwordx4 v[48:51], v56, s[48:51], s84 offen sc0 sc1
    s_mov_b64 exec, -1
L_nosig:

    s_waitcnt vmcnt(2)
    buffer_load_dwordx4 v[80:83], v9, s[40:43], s61 offen offset:0 nt
    s_cmp_ge_u32 s5, 2
    s_cbranch_scc1 L_noq
    v_lshrrev_b32 v18, 2, v2
    v_lshl_add_u32 v18, v3, 3, v18
    v_lshlrev_b32 v18, 7, v18
    v_and_b32 v29, 3, v2
    v_lshl_add_u32 v18, v29, 3, v18

    s_lshl_b32 s10, s5, 6
    v_add_u32 v18, s10, v18
    v_and_b32 v10, 7, v2
    v_mul_u32_u24 v19, 272, v10
    v_lshl_add_u32 v19, v3, 4, v19
    v_lshlrev_b32 v10, 13, v10
    v_lshrrev_b32 v11, 3, v2
    v_lshl_add_u32 v10, v11, 6, v10
    v_lshl_add_u32 v10, v3, 4, v10
    v_cmp_lt_u32 vcc, 7, v2
    s_lshl_b32 s10, s3, 16
    s_lshl_b32 s11, s7, 11
    s_add_u32 s10, s10, s11
    s_lshl_b32 s11, s6, 8
    s_add_u32 s10, s10, s11
    s_lshl_b32 s11, s5, 7
    s_add_u32 s10, s10, s11
    s_add_u32 s10, s10, 65536

L_lw1:
    ds_read_b32 v58, v56 offset:17664
    s_waitcnt lgkmcnt(0)
    v_readfirstlane_b32 s64, v58
    s_nop 0
    s_cmp_lt_u32 s64, 8
    s_cbranch_scc1 L_lw1

    ds_read_b128 v[232:235], v19 offset:18432
    ds_read_b128 v[236:239], v19 offset:18496
    ds_read_b128 v[240:243], v19 offset:18560
    ds_read_b128 v[244:247], v19 offset:18624
    ds_read_b64_tr_b16 v[192:193], v18 offset:0
    ds_read_b64_tr_b16 v[194:195], v18 offset:512
    ds_read_b64_tr_b16 v[208:209], v18 offset:32
    ds_read_b64_tr_b16 v[210:211], v18 offset:544
    ds_read_b64_tr_b16 v[196:197], v18 offset:4096
    ds_read_b64_tr_b16 v[198:199], v18 offset:4608
    ds_read_b64_tr_b16 v[212:213], v18 offset:4128
    ds_read_b64_tr_b16 v[214:215], v18 offset:4640
    s_waitcnt lgkmcnt(0)
    ds_read_b64_tr_b16 v[200:201], v18 offset:8192
    ds_read_b64_tr_b16 v[202:203], v18 offset:8704
    ds_read_b64_tr_b16 v[216:217], v18 offset:8224
    ds_read_b64_tr_b16 v[218:219], v18 offset:8736
    ds_read_b64_tr_b16 v[204:205], v18 offset:12288
    ds_read_b64_tr_b16 v[206:207], v18 offset:12800
    ds_read_b64_tr_b16 v[220:221], v18 offset:12320
    ds_read_b64_tr_b16 v[222:223], v18 offset:12832
    s_waitcnt lgkmcnt(0)
    v_mfma_f32_16x16x32_bf16 v[224:227], v[192:195], v[232:235], 0
    v_mfma_f32_16x16x32_bf16 v[228:231], v[208:211], v[232:235], 0
    v_mfma_f32_16x16x32_bf16 v[224:227], v[196:199], v[236:239], v[224:227]
    v_mfma_f32_16x16x32_bf16 v[228:231], v[212:215], v[236:239], v[228:231]
    v_mfma_f32_16x16x32_bf16 v[224:227], v[200:203], v[240:243], v[224:227]
    v_mfma_f32_16x16x32_bf16 v[228:231], v[216:219], v[240:243], v[228:231]
    v_mfma_f32_16x16x32_bf16 v[224:227], v[204:207], v[244:247], v[224:227]
    v_mfma_f32_16x16x32_bf16 v[228:231], v[220:223], v[244:247], v[228:231]
    s_nop 7
    v_cndmask_b32 v48, v224, v228, vcc
    v_cndmask_b32 v49, v225, v229, vcc
    v_cndmask_b32 v50, v226, v230, vcc
    v_cndmask_b32 v51, v227, v231, vcc
    v_bfi_b32 v48, s9, v4, v48
    v_bfi_b32 v49, s9, v5, v49
    v_bfi_b32 v50, s9, v6, v50
    v_bfi_b32 v51, s9, v7, v51
    v_add_u32 v60, s10, v10
    buffer_store_dwordx4 v[48:51], v60, s[48:51], 0 offen
L_noq:
    s_waitcnt vmcnt(2)
    buffer_load_dwordx4 v[84:87], v9, s[40:43], s61 offen offset:128 nt
    s_waitcnt vmcnt(2)
    buffer_load_dwordx4 v[88:91], v9, s[40:43], s61 offen offset:2048 nt
    s_waitcnt vmcnt(2)
    buffer_load_dwordx4 v[92:95], v9, s[40:43], s61 offen offset:2176 nt
    s_waitcnt vmcnt(2)
    buffer_load_dwordx4 v[96:99], v9, s[40:43], s62 offen offset:0 nt
    s_waitcnt vmcnt(2)
    buffer_load_dwordx4 v[100:103], v9, s[40:43], s62 offen offset:128 nt
    v_and_b32 v61, 31, v1
    v_lshlrev_b32 v61, 4, v61
    s_cmp_eq_u32 s5, 6
    s_cselect_b32 s84, s83, 805306368
    buffer_load_dwordx4 v[40:43], v61, s[48:51], s84 offen sc1
    s_waitcnt vmcnt(3)
    buffer_load_dwordx4 v[104:107], v9, s[40:43], s62 offen offset:2048 nt
    s_waitcnt vmcnt(3)
    buffer_load_dwordx4 v[108:111], v9, s[40:43], s62 offen offset:2176 nt
    s_waitcnt vmcnt(3)
    buffer_load_dwordx4 v[112:115], v9, s[40:43], s63 offen offset:0 nt
    s_waitcnt vmcnt(3)
    s_cmp_lg_u32 s5, 6
    s_cbranch_scc1 L_lc2
    s_mov_b32 s64, 0
L_lc1:
    v_cmp_ne_u32 vcc, s8, v43
    s_add_u32 s64, s64, 1
    s_cmp_eq_u64 vcc, 0
    s_cbranch_scc1 L_lc3
    s_mov_b32 s82, 1
    s_cmp_gt_u32 s64, 8
    s_cbranch_scc1 L_lc4
    buffer_load_dwordx4 v[40:43], v61, s[48:51], s84 offen sc1
    s_waitcnt vmcnt(0)
    s_branch L_lc1
L_lc3:
    v_cmp_ne_u32 vcc, s75, v40
    s_nop 0
    s_cmp_eq_u64 vcc, 0
    s_cselect_b32 s82, 2, 1
L_lc4:
    v_mov_b32 v59, s82
    s_mov_b64 exec, 1
    ds_write_b32 v56, v59 offset:17684
    s_mov_b64 exec, -1
L_lc2:

    s_waitcnt vmcnt(2)
    buffer_load_dwordx4 v[116:119], v9, s[40:43], s63 offen offset:128 nt
    s_cmp_ge_u32 s5, 2
    s_cbranch_scc1 L_noq2
L_lw2:
    ds_read_b32 v58, v56 offset:17684
    s_waitcnt lgkmcnt(0)
    v_readfirstlane_b32 s64, v58
    s_nop 0
    s_cmp_lt_u32 s64, 1
    s_cbranch_scc1 L_lw2

    s_cmp_eq_u32 s64, 2
    s_cbranch_scc1 L_noq2
    buffer_store_dwordx4 v[48:51], v60, s[48:51], 0 offen sc0 sc1
L_noq2:

    s_lshl_b32 s10, s3, 3
    s_add_u32 s10, s10, s6
    s_lshl_b32 s10, s10, 13
    s_lshl_b32 s11, s5, 8
    s_add_u32 s10, s10, s11
    s_add_u32 s15, s10, 65536
    v_lshlrev_b32 v20, 11, v3
    v_lshl_add_u32 v20, v2, 4, v20

    buffer_load_dwordx4 v[52:55], v20, s[48:51], s15 offen sc1
    s_waitcnt vmcnt(3)
    buffer_load_dwordx4 v[120:123], v9, s[40:43], s63 offen offset:2048 nt
    s_waitcnt vmcnt(3)
    buffer_load_dwordx4 v[124:127], v9, s[40:43], s63 offen offset:2176 nt
    s_waitcnt vmcnt(3)
    buffer_load_dwordx4 v[128:131], v8, s[44:47], s60 offen offset:0 nt
    s_waitcnt vmcnt(3)
    s_mov_b32 s64, 0
L_pc3:
    v_xor_b32 v52, v4, v52
    v_xor_b32 v53, v5, v53
    v_xor_b32 v54, v6, v54
    v_xor_b32 v55, v7, v55
    v_or3_b32 v31, v52, v53, v54
    v_or_b32 v31, v31, v55
    v_cmp_ne_u32_sdwa vcc, v31, v56 src0_sel:BYTE_0 src1_sel:DWORD
    s_cmp_lg_u64 vcc, 0
    s_cbranch_scc1 L_pr4
L_pd5:
    v_mov_b32 v24, v52
    v_mov_b32 v25, v53
    v_mov_b32 v26, v54
    v_mov_b32 v27, v55
    v_permlane16_swap_b32 v52, v24
    v_permlane16_swap_b32 v53, v25
    v_permlane16_swap_b32 v54, v26
    v_permlane16_swap_b32 v55, v27
    v_add_f32 v52, v52, v24
    v_add_f32 v53, v53, v25
    v_add_f32 v54, v54, v26
    v_add_f32 v55, v55, v27
    v_mov_b32 v24, v52
    v_mov_b32 v25, v53
    v_mov_b32 v26, v54
    v_mov_b32 v27, v55
    v_permlane32_swap_b32 v52, v24
    v_permlane32_swap_b32 v53, v25
    v_permlane32_swap_b32 v54, v26
    v_permlane32_swap_b32 v55, v27
    v_add_f32 v52, v52, v24
    v_add_f32 v53, v53, v25
    v_add_f32 v54, v54, v26
    v_add_f32 v55, v55, v27
    v_cvt_pk_bf16_f32 v52, v52, v53
    v_cvt_pk_bf16_f32 v53, v54, v55
    s_lshl_b32 s10, s5, 7
    v_lshl_add_u32 v14, v2, 3, s10
    s_mov_b64 exec, 0xffff
    ds_write_b64 v14, v[52:53] offset:16384
    s_mov_b64 exec, -1

    s_mov_b64 exec, 1
    ds_add_u32 v56, v57 offset:17668
    s_mov_b64 exec, -1
    s_waitcnt vmcnt(2)
    buffer_load_dwordx4 v[132:135], v8, s[44:47], s60 offen offset:1024 nt
    s_waitcnt vmcnt(5)
    s_bitcmp1_b32 s85, 0
    s_cbranch_scc0 L_ev6
    s_waitcnt vmcnt(2)
L_ev6:
    buffer_load_dwordx4 v[136:139], v8, s[44:47], s60 offen offset:2048 nt
    s_waitcnt vmcnt(4)
    s_bitcmp1_b32 s85, 0
    s_cbranch_scc0 L_ev7
    s_waitcnt vmcnt(2)
L_ev7:
    buffer_load_dwordx4 v[140:143], v8, s[44:47], s60 offen offset:3072 nt
    v_and_b32 v10, 3, v2
    v_lshlrev_b32 v10, 8, v10
    v_bfe_u32 v11, v2, 2, 1
    v_lshl_add_u32 v10, v11, 6, v10
    v_lshl_add_u32 v10, v3, 4, v10
    v_cmp_eq_u32 s[66:67], 1, v11
    s_mov_b32 s70, 0x3db504f3
    s_mov_b32 s71, 0x3fb8aa3b
    s_mov_b32 s72, 0x05040100
    s_mov_b32 s73, 0x07060302

L_lw8:
    ds_read_b32 v58, v56 offset:17668
    s_waitcnt lgkmcnt(0)
    v_readfirstlane_b32 s64, v58
    s_nop 0
    s_cmp_lt_u32 s64, 8
    s_cbranch_scc1 L_lw8

    ds_read_b128 v[40:43], v10 offset:16384
    ds_read_b128 v[44:47], v10 offset:16512
    s_waitcnt vmcnt(5)
    s_bitcmp1_b32 s85, 0
    s_cbranch_scc0 L_ev9
    s_waitcnt vmcnt(2)
L_ev9:
    buffer_load_dwordx4 v[144:147], v8, s[44:47], s61 offen offset:0 nt
    s_waitcnt vmcnt(10)
    s_waitcnt lgkmcnt(0)
    v_mfma_f32_16x16x32_bf16 v[192:195], v[64:67], v[40:43], 0
    v_mfma_f32_16x16x32_bf16 v[196:199], v[72:75], v[40:43], 0
    v_mfma_f32_16x16x32_bf16 v[200:203], v[80:83], v[40:43], 0
    v_mfma_f32_16x16x32_bf16 v[204:207], v[88:91], v[40:43], 0
    v_mfma_f32_16x16x32_bf16 v[208:211], v[96:99], v[40:43], 0
    v_mfma_f32_16x16x32_bf16 v[212:215], v[104:107], v[40:43], 0
    v_mfma_f32_16x16x32_bf16 v[192:195], v[68:71], v[44:47], v[192:195]
    v_mfma_f32_16x16x32_bf16 v[196:199], v[76:79], v[44:47], v[196:199]
    v_mfma_f32_16x16x32_bf16 v[200:203], v[84:87], v[44:47], v[200:203]
    v_mfma_f32_16x16x32_bf16 v[204:207], v[92:95], v[44:47], v[204:207]
    v_mfma_f32_16x16x32_bf16 v[208:211], v[100:103], v[44:47], v[208:211]
    v_mfma_f32_16x16x32_bf16 v[212:215], v[108:111], v[44:47], v[212:215]
    s_waitcnt vmcnt(5)
    s_bitcmp1_b32 s85, 0
    s_cbranch_scc0 L_ev10
    s_waitcnt vmcnt(2)
L_ev10:
    buffer_load_dwordx4 v[148:151], v8, s[44:47], s61 offen offset:1024 nt
    s_waitcnt vmcnt(6)
    v_mfma_f32_16x16x32_bf16 v[216:219], v[112:115], v[40:43], 0
    v_mfma_f32_16x16x32_bf16 v[220:223], v[120:123], v[40:43], 0
    v_mfma_f32_16x16x32_bf16 v[216:219], v[116:119], v[44:47], v[216:219]
    v_mfma_f32_16x16x32_bf16 v[220:223], v[124:127], v[44:47], v[220:223]
    v_cndmask_b32 v192, v192, v193, s[66:67]
    v_cndmask_b32 v194, v194, v195, s[66:67]
    v_cndmask_b32 v196, v196, v197, s[66:67]
    v_cndmask_b32 v198, v198, v199, s[66:67]
    v_cndmask_b32 v200, v200, v201, s[66:67]
    v_cndmask_b32 v202, v202, v203, s[66:67]
    v_cndmask_b32 v204, v204, v205, s[66:67]
    v_cndmask_b32 v206, v206, v207, s[66:67]
    v_cndmask_b32 v208, v208, v209, s[66:67]
    v_cndmask_b32 v210, v210, v211, s[66:67]
    v_cndmask_b32 v212, v212, v213, s[66:67]
    v_cndmask_b32 v214, v214, v215, s[66:67]
    v_cndmask_b32 v216, v216, v217, s[66:67]
    v_cndmask_b32 v218, v218, v219, s[66:67]
    v_cndmask_b32 v220, v220, v221, s[66:67]
    v_cndmask_b32 v222, v222, v223, s[66:67]
    v_add_f32_dpp v64, v192, v192 row_ror:4 row_mask:0xf bank_mask:0xf
    v_add_f32_dpp v65, v194, v194 row_ror:4 row_mask:0xf bank_mask:0xf
    v_add_f32_dpp v66, v196, v196 row_ror:4 row_mask:0xf bank_mask:0xf
    v_add_f32_dpp v67, v198, v198 row_ror:4 row_mask:0xf bank_mask:0xf
    v_add_f32_dpp v68, v200, v200 row_ror:4 row_mask:0xf bank_mask:0xf
    v_add_f32_dpp v69, v202, v202 row_ror:4 row_mask:0xf bank_mask:0xf
    v_add_f32_dpp v70, v204, v204 row_ror:4 row_mask:0xf bank_mask:0xf
    v_add_f32_dpp v71, v206, v206 row_ror:4 row_mask:0xf bank_mask:0xf
    v_add_f32_dpp v72, v208, v208 row_ror:4 row_mask:0xf bank_mask:0xf
    v_add_f32_dpp v73, v210, v210 row_ror:4 row_mask:0xf bank_mask:0xf
    v_add_f32_dpp v74, v212, v212 row_ror:4 row_mask:0xf bank_mask:0xf
    v_add_f32_dpp v75, v214, v214 row_ror:4 row_mask:0xf bank_mask:0xf
    v_add_f32_dpp v76, v216, v216 row_ror:4 row_mask:0xf bank_mask:0xf
    v_add_f32_dpp v77, v218, v218 row_ror:4 row_mask:0xf bank_mask:0xf
    v_add_f32_dpp v78, v220, v220 row_ror:4 row_mask:0xf bank_mask:0xf
    v_add_f32_dpp v79, v222, v222 row_ror:4 row_mask:0xf bank_mask:0xf
    s_waitcnt vmcnt(5)
    s_bitcmp1_b32 s85, 0
    s_cbranch_scc0 L_ev11
    s_waitcnt vmcnt(2)
L_ev11:
    buffer_load_dwordx4 v[152:155], v8, s[44:47], s61 offen offset:2048 nt
    v_cvt_pk_bf16_f32 v12, v64, v65
    v_lshlrev_b32 v64, 16, v12
    v_and_b32 v65, 0xffff0000, v12
    v_mul_f32 v64, s70, v64
    v_mul_f32 v65, s70, v65
    v_cvt_pk_bf16_f32 v12, v64, v65
    v_lshlrev_b32 v64, 16, v12
    v_and_b32 v65, 0xffff0000, v12

    v_cvt_pk_bf16_f32 v12, v66, v67
    v_lshlrev_b32 v66, 16, v12
    v_and_b32 v67, 0xffff0000, v12
    v_mul_f32 v66, s70, v66
    v_mul_f32 v67, s70, v67
    v_cvt_pk_bf16_f32 v12, v66, v67
    v_lshlrev_b32 v66, 16, v12
    v_and_b32 v67, 0xffff0000, v12

    v_cvt_pk_bf16_f32 v12, v68, v69
    v_lshlrev_b32 v68, 16, v12
    v_and_b32 v69, 0xffff0000, v12
    v_mul_f32 v68, s70, v68
    v_mul_f32 v69, s70, v69
    v_cvt_pk_bf16_f32 v12, v68, v69
    v_lshlrev_b32 v68, 16, v12
    v_and_b32 v69, 0xffff0000, v12

    v_cvt_pk_bf16_f32 v12, v70, v71
    v_lshlrev_b32 v70, 16, v12
    v_and_b32 v71, 0xffff0000, v12
    v_mul_f32 v70, s70, v70
    v_mul_f32 v71, s70, v71
    v_cvt_pk_bf16_f32 v12, v70, v71
    v_lshlrev_b32 v70, 16, v12
    v_and_b32 v71, 0xffff0000, v12

    v_cvt_pk_bf16_f32 v12, v72, v73
    v_lshlrev_b32 v72, 16, v12
    v_and_b32 v73, 0xffff0000, v12
    v_mul_f32 v72, s70, v72
    v_mul_f32 v73, s70, v73
    v_cvt_pk_bf16_f32 v12, v72, v73
    v_lshlrev_b32 v72, 16, v12
    v_and_b32 v73, 0xffff0000, v12

    v_cvt_pk_bf16_f32 v12, v74, v75
    v_lshlrev_b32 v74, 16, v12
    v_and_b32 v75, 0xffff0000, v12
    v_mul_f32 v74, s70, v74
    v_mul_f32 v75, s70, v75
    v_cvt_pk_bf16_f32 v12, v74, v75
    v_lshlrev_b32 v74, 16, v12
    v_and_b32 v75, 0xffff0000, v12

    v_cvt_pk_bf16_f32 v12, v76, v77
    v_lshlrev_b32 v76, 16, v12
    v_and_b32 v77, 0xffff0000, v12
    v_mul_f32 v76, s70, v76
    v_mul_f32 v77, s70, v77
    v_cvt_pk_bf16_f32 v12, v76, v77
    v_lshlrev_b32 v76, 16, v12
    v_and_b32 v77, 0xffff0000, v12

    v_cvt_pk_bf16_f32 v12, v78, v79
    v_lshlrev_b32 v78, 16, v12
    v_and_b32 v79, 0xffff0000, v12
    v_mul_f32 v78, s70, v78
    v_mul_f32 v79, s70, v79
    v_cvt_pk_bf16_f32 v12, v78, v79
    v_lshlrev_b32 v78, 16, v12
    v_and_b32 v79, 0xffff0000, v12

    v_max3_f32 v13, v64, v65, v66
    v_max3_f32 v13, v13, v67, v68
    v_max3_f32 v13, v13, v69, v70
    v_max3_f32 v13, v13, v71, v72
    v_max3_f32 v13, v13, v73, v74
    v_max3_f32 v13, v13, v75, v76
    v_max3_f32 v13, v13, v77, v78
    v_max_f32 v13, v13, v79
    v_mov_b32 v24, v13
    s_nop 1
    v_permlane16_swap_b32 v13, v24
    v_max_f32 v13, v13, v24
    v_mov_b32 v24, v13
    s_nop 1
    v_permlane32_swap_b32 v13, v24
    v_max_f32 v13, v13, v24
    v_and_b32 v14, 3, v2
    v_lshlrev_b32 v14, 5, v14
    s_lshl_b32 s10, s5, 2
    v_add_u32 v15, s10, v14
    s_mov_b64 exec, 0xf
    ds_write_b32 v15, v13 offset:17408
    s_mov_b64 exec, -1

    s_mov_b64 exec, 1
    ds_add_u32 v56, v57 offset:17672
    s_mov_b64 exec, -1
    s_waitcnt vmcnt(5)
    s_bitcmp1_b32 s85, 0
    s_cbranch_scc0 L_ev12
    s_waitcnt vmcnt(2)
L_ev12:
    buffer_load_dwordx4 v[156:159], v8, s[44:47], s61 offen offset:3072 nt
    s_waitcnt vmcnt(5)
    s_bitcmp1_b32 s85, 0
    s_cbranch_scc0 L_ev13
    s_waitcnt vmcnt(2)
L_ev13:
    buffer_load_dwordx4 v[160:163], v8, s[44:47], s62 offen offset:0 nt
    s_waitcnt vmcnt(6)
    s_bitcmp1_b32 s85, 0
    s_cbranch_scc0 L_ev14
    s_waitcnt vmcnt(2)
L_ev14:
    buffer_load_dwordx4 v[164:167], v8, s[44:47], s62 offen offset:1024 nt
L_lw15:
    ds_read_b32 v58, v56 offset:17672
    s_waitcnt lgkmcnt(0)
    v_readfirstlane_b32 s64, v58
    s_nop 0
    s_cmp_lt_u32 s64, 8
    s_cbranch_scc1 L_lw15

    ds_read_b128 v[80:83], v14 offset:17408
    ds_read_b128 v[84:87], v14 offset:17424
    ds_read_b32 v58, v56 offset:17684
    s_waitcnt lgkmcnt(0)
    v_readfirstlane_b32 s26, v58
    v_max3_f32 v13, v80, v81, v82
    v_max3_f32 v13, v13, v83, v84
    v_max3_f32 v13, v13, v85, v86
    v_max_f32 v13, v13, v87

    s_lshr_b32 s26, s26, 1
    v_sub_f32 v64, v64, v13
    v_sub_f32 v65, v65, v13
    v_sub_f32 v66, v66, v13
    v_sub_f32 v67, v67, v13
    v_sub_f32 v68, v68, v13
    v_sub_f32 v69, v69, v13
    v_sub_f32 v70, v70, v13
    v_sub_f32 v71, v71, v13
    v_sub_f32 v72, v72, v13
    v_sub_f32 v73, v73, v13
    v_sub_f32 v74, v74, v13
    v_sub_f32 v75, v75, v13
    v_sub_f32 v76, v76, v13
    v_sub_f32 v77, v77, v13
    v_sub_f32 v78, v78, v13
    v_sub_f32 v79, v79, v13
    v_mul_f32 v64, s71, v64
    v_mul_f32 v65, s71, v65
    v_mul_f32 v66, s71, v66
    v_mul_f32 v67, s71, v67
    v_mul_f32 v68, s71, v68
    v_mul_f32 v69, s71, v69
    v_mul_f32 v70, s71, v70
    v_mul_f32 v71, s71, v71
    v_mul_f32 v72, s71, v72
    v_mul_f32 v73, s71, v73
    v_mul_f32 v74, s71, v74
    v_mul_f32 v75, s71, v75
    v_mul_f32 v76, s71, v76
    v_mul_f32 v77, s71, v77
    v_mul_f32 v78, s71, v78
    v_mul_f32 v79, s71, v79
    v_exp_f32 v64, v64
    v_exp_f32 v65, v65
    v_exp_f32 v66, v66
    v_exp_f32 v67, v67
    v_exp_f32 v68, v68
    v_exp_f32 v69, v69
    v_exp_f32 v70, v70
    v_exp_f32 v71, v71
    v_exp_f32 v72, v72
    v_exp_f32 v73, v73
    v_exp_f32 v74, v74
    v_exp_f32 v75, v75
    v_exp_f32 v76, v76
    v_exp_f32 v77, v77
    v_exp_f32 v78, v78
    v_exp_f32 v79, v79
    s_waitcnt vmcnt(5)
    s_bitcmp1_b32 s85, 0
    s_cbranch_scc0 L_ev16
    s_waitcnt vmcnt(2)
L_ev16:
    buffer_load_dwordx4 v[168:171], v8, s[44:47], s62 offen offset:2048 nt
    v_add_f32 v16, v64, v65
    v_add_f32 v17, v66, v67
    v_add_f32 v16, v16, v68
    v_add_f32 v17, v17, v69
    v_add_f32 v16, v16, v70
    v_add_f32 v17, v17, v71
    v_add_f32 v16, v16, v72
    v_add_f32 v17, v17, v73
    v_add_f32 v16, v16, v74
    v_add_f32 v17, v17, v75
    v_add_f32 v16, v16, v76
    v_add_f32 v17, v17, v77
    v_add_f32 v16, v16, v78
    v_add_f32 v17, v17, v79
    v_add_f32 v16, v16, v17
    v_mov_b32 v24, v16
    s_nop 1
    v_permlane16_swap_b32 v16, v24
    v_add_f32 v16, v16, v24
    v_mov_b32 v24, v16
    s_nop 1
    v_permlane32_swap_b32 v16, v24
    v_add_f32 v16, v16, v24
    s_mov_b64 exec, 0xf
    ds_write_b32 v15, v16 offset:17536
    s_mov_b64 exec, -1
    s_mov_b64 exec, 1
    ds_add_u32 v56, v57 offset:17676
    s_mov_b64 exec, -1
    v_cvt_pk_bf16_f32 v80, v64, v65
    v_cvt_pk_bf16_f32 v81, v66, v67
    v_cvt_pk_bf16_f32 v82, v68, v69
    v_cvt_pk_bf16_f32 v83, v70, v71
    v_cvt_pk_bf16_f32 v84, v72, v73
    v_cvt_pk_bf16_f32 v85, v74, v75
    v_cvt_pk_bf16_f32 v86, v76, v77
    v_cvt_pk_bf16_f32 v87, v78, v79
    v_lshrrev_b32 v17, 2, v2
    v_cmp_eq_u32 vcc, 0, v17
    s_nop 1
    v_cndmask_b32 v224, 0, v80, vcc
    v_cndmask_b32 v225, 0, v81, vcc
    v_cndmask_b32 v226, 0, v82, vcc
    v_cndmask_b32 v227, 0, v83, vcc
    v_cndmask_b32 v228, 0, v84, vcc
    v_cndmask_b32 v229, 0, v85, vcc
    v_cndmask_b32 v230, 0, v86, vcc
    v_cndmask_b32 v231, 0, v87, vcc
    v_cmp_eq_u32 vcc, 1, v17
    s_nop 1
    v_cndmask_b32 v232, 0, v80, vcc
    v_cndmask_b32 v233, 0, v81, vcc
    v_cndmask_b32 v234, 0, v82, vcc
    v_cndmask_b32 v235, 0, v83, vcc
    v_cndmask_b32 v236, 0, v84, vcc
    v_cndmask_b32 v237, 0, v85, vcc
    v_cndmask_b32 v238, 0, v86, vcc
    v_cndmask_b32 v239, 0, v87, vcc
    v_cmp_eq_u32 vcc, 2, v17
    s_nop 1
    v_cndmask_b32 v240, 0, v80, vcc
    v_cndmask_b32 v241, 0, v81, vcc
    v_cndmask_b32 v242, 0, v82, vcc
    v_cndmask_b32 v243, 0, v83, vcc
    v_cndmask_b32 v244, 0, v84, vcc
    v_cndmask_b32 v245, 0, v85, vcc
    v_cndmask_b32 v246, 0, v86, vcc
    v_cndmask_b32 v247, 0, v87, vcc
    v_cmp_eq_u32 vcc, 3, v17
    s_nop 1
    v_cndmask_b32 v248, 0, v80, vcc
    v_cndmask_b32 v249, 0, v81, vcc
    v_cndmask_b32 v250, 0, v82, vcc
    v_cndmask_b32 v251, 0, v83, vcc
    v_cndmask_b32 v252, 0, v84, vcc
    v_cndmask_b32 v253, 0, v85, vcc
    v_cndmask_b32 v254, 0, v86, vcc
    v_cndmask_b32 v255, 0, v87, vcc
    s_waitcnt vmcnt(5)
    s_bitcmp1_b32 s85, 0
    s_cbranch_scc0 L_ev17
    s_waitcnt vmcnt(2)
L_ev17:
    buffer_load_dwordx4 v[172:175], v8, s[44:47], s62 offen offset:3072 nt
    s_waitcnt vmcnt(9)
    s_bitcmp1_b32 s85, 0
    s_cbranch_scc0 L_ev18
    s_waitcnt vmcnt(2)
L_ev18:
    buffer_load_dwordx4 v[176:179], v8, s[44:47], s63 offen offset:0 nt
    s_waitcnt vmcnt(9)
    s_bitcmp1_b32 s85, 0
    s_cbranch_scc0 L_ev19
    s_waitcnt vmcnt(2)
L_ev19:
    buffer_load_dwordx4 v[180:183], v8, s[44:47], s63 offen offset:1024 nt
    s_waitcnt vmcnt(12)
    v_perm_b32 v96, v132, v128, s72
    v_perm_b32 v100, v132, v128, s73
    v_perm_b32 v104, v133, v129, s72
    v_perm_b32 v108, v133, v129, s73
    v_perm_b32 v112, v134, v130, s72
    v_perm_b32 v116, v134, v130, s73
    v_perm_b32 v120, v135, v131, s72
    v_perm_b32 v124, v135, v131, s73
    s_waitcnt vmcnt(10)
    v_perm_b32 v97, v140, v136, s72
    v_perm_b32 v101, v140, v136, s73
    v_perm_b32 v105, v141, v137, s72
    v_perm_b32 v109, v141, v137, s73
    v_perm_b32 v113, v142, v138, s72
    v_perm_b32 v117, v142, v138, s73
    v_perm_b32 v121, v143, v139, s72
    v_perm_b32 v125, v143, v139, s73
    s_waitcnt vmcnt(8)
    v_perm_b32 v98, v148, v144, s72
    v_perm_b32 v102, v148, v144, s73
    v_perm_b32 v106, v149, v145, s72
    v_perm_b32 v110, v149, v145, s73
    v_perm_b32 v114, v150, v146, s72
    v_perm_b32 v118, v150, v146, s73
    v_perm_b32 v122, v151, v147, s72
    v_perm_b32 v126, v151, v147, s73
    s_waitcnt vmcnt(6)
    v_perm_b32 v99, v156, v152, s72
    v_perm_b32 v103, v156, v152, s73
    v_perm_b32 v107, v157, v153, s72
    v_perm_b32 v111, v157, v153, s73
    v_perm_b32 v115, v158, v154, s72
    v_perm_b32 v119, v158, v154, s73
    v_perm_b32 v123, v159, v155, s72
    v_perm_b32 v127, v159, v155, s73
    v_mfma_f32_16x16x32_bf16 v[32:35], v[224:227], v[96:99], 0
    v_mfma_f32_16x16x32_bf16 v[36:39], v[224:227], v[100:103], 0
    v_mfma_f32_16x16x32_bf16 v[32:35], v[232:235], v[104:107], v[32:35]
    v_mfma_f32_16x16x32_bf16 v[36:39], v[232:235], v[108:111], v[36:39]
    v_mfma_f32_16x16x32_bf16 v[32:35], v[240:243], v[112:115], v[32:35]
    v_mfma_f32_16x16x32_bf16 v[36:39], v[240:243], v[116:119], v[36:39]
    v_mfma_f32_16x16x32_bf16 v[32:35], v[248:251], v[120:123], v[32:35]
    v_mfma_f32_16x16x32_bf16 v[36:39], v[248:251], v[124:127], v[36:39]
    s_waitcnt vmcnt(9)
    s_bitcmp1_b32 s85, 0
    s_cbranch_scc0 L_ev20
    s_waitcnt vmcnt(2)
L_ev20:
    buffer_load_dwordx4 v[184:187], v8, s[44:47], s63 offen offset:2048 nt
    s_waitcnt vmcnt(9)
    s_bitcmp1_b32 s85, 0
    s_cbranch_scc0 L_ev21
    s_waitcnt vmcnt(2)
L_ev21:
    buffer_load_dwordx4 v[188:191], v8, s[44:47], s63 offen offset:3072 nt
    v_lshrrev_b32 v23, 2, v2
    v_lshl_add_u32 v23, v3, 3, v23
    v_lshlrev_b32 v23, 7, v23
    v_and_b32 v29, 3, v2
    v_lshl_add_u32 v23, v29, 3, v23

    s_and_b32 s10, s5, 3
    v_and_b32 v11, 1, v3
    v_lshlrev_b32 v11, 1, v11
    v_lshrrev_b32 v12, 3, v2
    v_or_b32 v11, v11, v12
    v_xor_b32 v11, s10, v11
    v_lshl_add_u32 v23, v11, 5, v23
    v_and_b32 v61, 1, v3
    v_lshlrev_b32 v61, 1, v61
    v_and_b32 v12, 7, v1
    v_xor_b32 v61, v61, v12
    v_lshlrev_b32 v61, 4, v61

    s_mov_b32 s56, s24
    s_mov_b32 s57, s25
    s_mov_b32 s58, 0x400000
    s_mov_b32 s59, 0x20000
    v_bfe_u32 v11, v1, 3, 2
    v_lshl_add_u32 v11, v11, 17, v61
    v_lshrrev_b32 v12, 5, v1
    v_lshl_add_u32 v11, v12, 13, v11
    v_xor_b32 v60, 64, v11
    s_lshl_b32 s76, s3, 19
    s_lshr_b32 s11, s5, 1
    s_lshl_b32 s11, s11, 11
    s_add_u32 s76, s76, s11
    s_and_b32 s11, s5, 1
    s_lshl_b32 s11, s11, 16
    s_add_u32 s76, s76, s11
    s_lshl_b32 s77, s5, 12
    s_add_u32 s77, s77, 28672

    s_cmp_lg_u32 s5, 2
    s_cbranch_scc1 L_nostat
L_lw22:
    ds_read_b32 v58, v56 offset:17676
    s_waitcnt lgkmcnt(0)
    v_readfirstlane_b32 s64, v58
    s_nop 0
    s_cmp_lt_u32 s64, 8
    s_cbranch_scc1 L_lw22

    ds_read_b128 v[88:91], v14 offset:17536
    ds_read_b128 v[92:95], v14 offset:17552
    s_lshl_b32 s10, s3, 5
    s_add_u32 s10, s10, s4
    s_lshl_b32 s10, s10, 6
    s_add_u32 s10, s10, 589824
    s_waitcnt lgkmcnt(0)
    v_pk_add_f32 v[88:89], v[88:89], v[90:91]
    v_pk_add_f32 v[92:93], v[92:93], v[94:95]
    v_mov_b32 v48, v13
    v_pk_add_f32 v[88:89], v[88:89], v[92:93]
    v_mov_b32 v50, 0
    v_mov_b32 v51, s8
    v_add_f32 v49, v88, v89
    s_mov_b64 exec, 0xf

    buffer_store_dwordx4 v[48:51], v8, s[48:51], s10 offen
    s_cmp_lg_u32 s26, 0
    s_cbranch_scc1 L_pub23
    buffer_store_dwordx4 v[48:51], v8, s[48:51], s10 offen sc0 sc1
L_pub23:
    s_mov_b64 exec, -1
L_nostat:
    s_lshl_b32 s10, s5, 11
    v_add_u32 v10, s10, v8
    s_sub_u32 s11, s5, 4
    s_lshl_b32 s12, s11, 10
    v_add_u32 v22, s12, v8
    s_lshl_b32 s14, s3, 5
    s_add_u32 s14, s14, s4
    s_lshl_b32 s14, s14, 11
    s_add_u32 s14, s14, 655360
    s_lshl_b32 s10, s3, 3
    s_add_u32 s10, s10, s5
    s_lshl_b32 s65, s10, 8
    s_add_u32 s65, s65, 589824
    v_lshlrev_b32 v46, 4, v2
    s_mul_i32 s12, s5, 528
    v_lshlrev_b32 v16, 3, v1
    v_add_u32 v16, s12, v16
    v_and_b32 v17, 7, v2
    v_mul_u32_u24 v17, 528, v17
    v_lshl_add_u32 v17, v3, 4, v17
    v_lshrrev_b32 v18, 1, v2
    v_lshlrev_b32 v18, 16, v18
    v_and_b32 v19, 1, v2
    v_lshl_add_u32 v18, v19, 6, v18
    v_lshl_add_u32 v18, v3, 4, v18

    s_waitcnt vmcnt(6)
    v_perm_b32 v64, v164, v160, s72
    v_perm_b32 v68, v164, v160, s73
    v_perm_b32 v72, v165, v161, s72
    v_perm_b32 v76, v165, v161, s73
    v_perm_b32 v80, v166, v162, s72
    v_perm_b32 v84, v166, v162, s73
    v_perm_b32 v88, v167, v163, s72
    v_perm_b32 v92, v167, v163, s73
    s_lshl_b32 s101, s3, 5
    s_mov_b32 s99, 1
    s_cmp_lg_u32 s5, 3
    s_cbranch_scc1 L_notk
    s_atomic_add s99, s[36:37], s101 glc
L_notk:

    s_waitcnt vmcnt(4)
    v_perm_b32 v65, v172, v168, s72
    v_perm_b32 v69, v172, v168, s73
    v_perm_b32 v73, v173, v169, s72
    v_perm_b32 v77, v173, v169, s73
    v_perm_b32 v81, v174, v170, s72
    v_perm_b32 v85, v174, v170, s73
    v_perm_b32 v89, v175, v171, s72
    v_perm_b32 v93, v175, v171, s73
    s_waitcnt vmcnt(2)
    v_perm_b32 v66, v180, v176, s72
    v_perm_b32 v70, v180, v176, s73
    v_perm_b32 v74, v181, v177, s72
    v_perm_b32 v78, v181, v177, s73
    v_perm_b32 v82, v182, v178, s72
    v_perm_b32 v86, v182, v178, s73
    v_perm_b32 v90, v183, v179, s72
    v_perm_b32 v94, v183, v179, s73
    s_cmp_lg_u32 s5, 3
    s_cbranch_scc1 L_ntw
    s_waitcnt lgkmcnt(0)
    s_and_b32 s99, s99, 31
    s_add_u32 s99, s99, 1
    v_mov_b32 v59, s99
    s_mov_b64 exec, 1
    ds_write_b32 v56, v59 offset:17696
    s_mov_b64 exec, -1

L_ntw:
L_lw24:
    ds_read_b32 v58, v56 offset:17696
    s_waitcnt lgkmcnt(0)
    v_readfirstlane_b32 s64, v58
    s_nop 0
    s_cmp_lt_u32 s64, 1
    s_cbranch_scc1 L_lw24

    s_sub_u32 s99, s64, 1
    s_mov_b32 m0, s77
    s_bfe_u32 s7, s99, 0x10003
    s_and_b32 s6, s99, 7
    s_lshl_b32 s78, s7, 10
    s_add_u32 s76, s76, s78
    s_lshl_b32 s78, s6, 7
    s_add_u32 s76, s76, s78

    s_waitcnt vmcnt(0)
    v_perm_b32 v67, v188, v184, s72
    v_perm_b32 v75, v189, v185, s72
    v_perm_b32 v83, v190, v186, s72
    v_mfma_f32_16x16x32_bf16 v[32:35], v[228:231], v[64:67], v[32:35]
    v_perm_b32 v91, v191, v187, s72
    v_mfma_f32_16x16x32_bf16 v[32:35], v[236:239], v[72:75], v[32:35]
    v_perm_b32 v71, v188, v184, s73
    v_mfma_f32_16x16x32_bf16 v[32:35], v[244:247], v[80:83], v[32:35]
    v_perm_b32 v79, v189, v185, s73
    v_mfma_f32_16x16x32_bf16 v[32:35], v[252:255], v[88:91], v[32:35]
    v_perm_b32 v87, v190, v186, s73
    v_mfma_f32_16x16x32_bf16 v[36:39], v[228:231], v[68:71], v[36:39]
    v_perm_b32 v95, v191, v187, s73
    v_mfma_f32_16x16x32_bf16 v[36:39], v[236:239], v[76:79], v[36:39]
    v_mfma_f32_16x16x32_bf16 v[36:39], v[244:247], v[84:87], v[36:39]
    v_mfma_f32_16x16x32_bf16 v[36:39], v[252:255], v[92:95], v[36:39]
    s_nop 1
    ds_write_b128 v10, v[32:35] offset:0
    s_nop 4
    ds_write_b128 v10, v[36:39] offset:1024

    s_cmp_ge_u32 s99, 16
    s_cbranch_scc1 L_nowd
    buffer_load_dwordx4 v11, s[56:59], s76 offen nt lds
    s_add_u32 m0, m0, 1024
    s_add_u32 s76, s76, 16384
    buffer_load_dwordx4 v60, s[56:59], s76 offen nt lds
    s_add_u32 m0, m0, 1024
    s_add_u32 s76, s76, 16384
    buffer_load_dwordx4 v11, s[56:59], s76 offen nt lds
    s_add_u32 m0, m0, 1024
    s_add_u32 s76, s76, 16384
    buffer_load_dwordx4 v60, s[56:59], s76 offen nt lds
L_nowd:
    s_cmp_ge_u32 s11, 2
    s_waitcnt lgkmcnt(0)
    s_barrier
    s_cbranch_scc1 L_noored
    ds_read_b128 v[64:67], v22 offset:0
    ds_read_b128 v[68:71], v22 offset:2048
    ds_read_b128 v[72:75], v22 offset:4096
    ds_read_b128 v[76:79], v22 offset:6144
    ds_read_b128 v[80:83], v22 offset:8192
    ds_read_b128 v[84:87], v22 offset:10240
    ds_read_b128 v[88:91], v22 offset:12288
    ds_read_b128 v[92:95], v22 offset:14336
    s_waitcnt lgkmcnt(6)
    v_pk_add_f32 v[64:65], v[64:65], v[68:69]
    v_pk_add_f32 v[66:67], v[66:67], v[70:71]
    s_waitcnt lgkmcnt(4)
    v_pk_add_f32 v[72:73], v[72:73], v[76:77]
    v_pk_add_f32 v[74:75], v[74:75], v[78:79]
    v_pk_add_f32 v[64:65], v[64:65], v[72:73]
    v_pk_add_f32 v[66:67], v[66:67], v[74:75]
    s_waitcnt lgkmcnt(2)
    v_pk_add_f32 v[80:81], v[80:81], v[84:85]
    v_pk_add_f32 v[82:83], v[82:83], v[86:87]
    v_pk_add_f32 v[64:65], v[64:65], v[80:81]
    v_pk_add_f32 v[66:67], v[66:67], v[82:83]
    s_waitcnt lgkmcnt(0)
    v_pk_add_f32 v[88:89], v[88:89], v[92:93]
    v_pk_add_f32 v[90:91], v[90:91], v[94:95]
    v_pk_add_f32 v[100:101], v[64:65], v[88:89]
    v_pk_add_f32 v[102:103], v[66:67], v[90:91]
    v_bfi_b32 v100, s9, v4, v100
    v_bfi_b32 v101, s9, v5, v101
    v_bfi_b32 v102, s9, v6, v102
    v_bfi_b32 v103, s9, v7, v103
    buffer_store_dwordx4 v[100:103], v22, s[48:51], s14 offen
    s_cmp_lg_u32 s26, 0
    s_cbranch_scc1 L_pub25
    buffer_store_dwordx4 v[100:103], v22, s[48:51], s14 offen sc0 sc1
L_pub25:
L_noored:
    s_barrier
    s_cmp_ge_u32 s99, 16
    s_cbranch_scc1 L_F
    buffer_load_dwordx4 v[52:55], v46, s[48:51], s65 offen sc1

    s_lshl_b32 s100, s99, 3
    s_or_b32 s100, s100, s5
    s_cmp_lg_u32 s100, 35
    s_cbranch_scc1 L_nofs
    s_mov_b32 s100, 1
    s_atomic_add s100, s[36:37], 16 glc
    s_lshl_b32 s101, s3, 7
    s_add_u32 s101, s101, 622592
    v_mov_b32 v43, s8
    s_waitcnt lgkmcnt(0)
    s_and_b32 s100, s100, 7
    v_mov_b32 v40, s100
    s_mov_b64 exec, 1

    buffer_store_dwordx4 v[40:43], v56, s[48:51], s101 offen
    s_cmp_lg_u32 s26, 0
    s_cbranch_scc1 L_pub26
    buffer_store_dwordx4 v[40:43], v56, s[48:51], s101 offen sc0 sc1
L_pub26:
    s_mov_b64 exec, -1
L_nofs:
    s_lshl_b32 s12, s10, 13
    s_lshl_b32 s13, s7, 10
    s_add_u32 s12, s12, s13
    s_lshl_b32 s10, s6, 1
    s_bfe_u32 s11, s5, 0x10001
    s_add_u32 s10, s10, s11
    s_lshl_b32 s11, s3, 1
    s_add_u32 s11, s11, s7

    s_lshl_b32 s10, s10, 4
    s_add_u32 s10, s10, s11
    s_lshl_b32 s10, s10, 8
    s_and_b32 s11, s5, 1
    s_lshl_b32 s11, s11, 7
    s_add_u32 s10, s10, s11
    s_add_u32 s10, s10, 1179648
    s_add_u32 s12, s12, 655360
    s_add_u32 s13, s12, 4096

    s_waitcnt vmcnt(3)
    buffer_load_dwordx4 v[64:67], v8, s[48:51], s12 offen offset:0 sc1
    buffer_load_dwordx4 v[68:71], v8, s[48:51], s12 offen offset:2048 sc1
    buffer_load_dwordx4 v[72:75], v8, s[48:51], s13 offen offset:0 sc1
    buffer_load_dwordx4 v[76:79], v8, s[48:51], s13 offen offset:2048 sc1
    s_waitcnt vmcnt(5)
    s_cmp_ge_u32 s5, 4
    s_barrier
    s_cbranch_scc1 L_Wnt
    ds_read_b64_tr_b16 v[192:193], v23 offset:28672
    ds_read_b64_tr_b16 v[194:195], v23 offset:29184
    ds_read_b64_tr_b16 v[196:197], v23 offset:32768
    ds_read_b64_tr_b16 v[198:199], v23 offset:33280
    ds_read_b64_tr_b16 v[200:201], v23 offset:36864
    ds_read_b64_tr_b16 v[202:203], v23 offset:37376
    ds_read_b64_tr_b16 v[204:205], v23 offset:40960
    ds_read_b64_tr_b16 v[206:207], v23 offset:41472
    ds_read_b64_tr_b16 v[208:209], v23 offset:45056
    ds_read_b64_tr_b16 v[210:211], v23 offset:45568
    ds_read_b64_tr_b16 v[212:213], v23 offset:49152
    ds_read_b64_tr_b16 v[214:215], v23 offset:49664
    ds_read_b64_tr_b16 v[216:217], v23 offset:53248
    ds_read_b64_tr_b16 v[218:219], v23 offset:53760
    s_waitcnt lgkmcnt(8)
    ds_read_b64_tr_b16 v[220:221], v23 offset:57344
    ds_read_b64_tr_b16 v[222:223], v23 offset:57856
L_Wnt:
    s_waitcnt vmcnt(4)
    s_mov_b32 s64, 0
L_pc27:
    v_cmp_ne_u32 vcc, s8, v55
    s_cmp_lg_u64 vcc, 0
    s_cbranch_scc1 L_pr28
L_pd29:
    v_max_f32_dpp v12, v52, v52 row_ror:4 row_mask:0xf bank_mask:0xf
    s_nop 1
    v_max_f32_dpp v12, v12, v12 row_ror:8 row_mask:0xf bank_mask:0xf
    v_sub_f32 v13, v52, v12
    v_mul_f32 v13, s71, v13
    v_exp_f32 v13, v13
    s_nop 0
    v_mul_f32 v14, v13, v53
    s_nop 1
    v_add_f32_dpp v15, v14, v14 row_ror:4 row_mask:0xf bank_mask:0xf
    s_nop 1
    v_add_f32_dpp v15, v15, v15 row_ror:8 row_mask:0xf bank_mask:0xf
    v_rcp_f32 v15, v15
    s_nop 0
    v_mul_f32 v13, v13, v15
    s_nop 0

    v_readlane_b32 s76, v13, 0
    v_readlane_b32 s77, v13, 1
    v_readlane_b32 s78, v13, 2
    v_readlane_b32 s79, v13, 3
    v_readlane_b32 s80, v13, 4
    v_readlane_b32 s81, v13, 5
    v_readlane_b32 s82, v13, 6
    v_readlane_b32 s83, v13, 7
    v_readlane_b32 s84, v13, 8
    v_readlane_b32 s85, v13, 9
    v_readlane_b32 s86, v13, 10
    v_readlane_b32 s87, v13, 11
    v_readlane_b32 s88, v13, 12
    v_readlane_b32 s89, v13, 13
    v_readlane_b32 s90, v13, 14
    v_readlane_b32 s91, v13, 15
    s_mov_b32 s64, 0
L_pc30:
    s_waitcnt vmcnt(3)
    v_xor_b32 v64, v4, v64
    v_xor_b32 v65, v5, v65
    v_xor_b32 v66, v6, v66
    v_xor_b32 v67, v7, v67
    v_or3_b32 v31, v64, v65, v66
    v_or_b32 v31, v31, v67
    s_waitcnt vmcnt(2)
    v_xor_b32 v68, v4, v68
    v_xor_b32 v69, v5, v69
    v_xor_b32 v70, v6, v70
    v_xor_b32 v71, v7, v71
    v_or3_b32 v31, v31, v68, v69
    v_or3_b32 v31, v31, v70, v71
    s_waitcnt vmcnt(1)
    v_xor_b32 v72, v4, v72
    v_xor_b32 v73, v5, v73
    v_xor_b32 v74, v6, v74
    v_xor_b32 v75, v7, v75
    v_or3_b32 v31, v31, v72, v73
    v_or3_b32 v31, v31, v74, v75
    s_waitcnt vmcnt(0)
    v_xor_b32 v76, v4, v76
    v_xor_b32 v77, v5, v77
    v_xor_b32 v78, v6, v78
    v_xor_b32 v79, v7, v79
    v_or3_b32 v31, v31, v76, v77
    v_or3_b32 v31, v31, v78, v79
    v_cmp_ne_u32_sdwa vcc, v31, v56 src0_sel:BYTE_0 src1_sel:DWORD
    s_cmp_lg_u64 vcc, 0
    s_cbranch_scc1 L_pr31
L_pd32:
    v_pk_mul_f32 v[64:65], v[64:65], s[76:77]
    v_pk_mul_f32 v[66:67], v[66:67], s[78:79]
    v_pk_fma_f32 v[64:65], v[68:69], s[80:81], v[64:65]
    v_pk_fma_f32 v[66:67], v[70:71], s[82:83], v[66:67]
    v_pk_fma_f32 v[64:65], v[72:73], s[84:85], v[64:65]
    v_pk_fma_f32 v[66:67], v[74:75], s[86:87], v[66:67]
    v_pk_fma_f32 v[64:65], v[76:77], s[88:89], v[64:65]
    v_pk_fma_f32 v[66:67], v[78:79], s[90:91], v[66:67]
    v_cvt_pk_bf16_f32 v68, v64, v65
    v_cvt_pk_bf16_f32 v69, v66, v67
    ds_write_b64 v16, v[68:69] offset:18432
    s_cmp_ge_u32 s5, 4
    s_waitcnt lgkmcnt(0)
    s_barrier
    s_cbranch_scc1 L_H

    ds_read_b128 v[64:67], v17 offset:18432
    ds_read_b128 v[68:71], v17 offset:18496
    ds_read_b128 v[72:75], v17 offset:18560
    ds_read_b128 v[76:79], v17 offset:18624
    ds_read_b128 v[80:83], v17 offset:18688
    ds_read_b128 v[84:87], v17 offset:18752
    ds_read_b128 v[88:91], v17 offset:18816
    ds_read_b128 v[92:95], v17 offset:18880
    s_waitcnt lgkmcnt(7)
    v_mfma_f32_16x16x32_bf16 v[32:35], v[192:195], v[64:67], 0
    s_waitcnt lgkmcnt(6)
    v_mfma_f32_16x16x32_bf16 v[32:35], v[196:199], v[68:71], v[32:35]
    s_waitcnt lgkmcnt(5)
    v_mfma_f32_16x16x32_bf16 v[32:35], v[200:203], v[72:75], v[32:35]
    s_waitcnt lgkmcnt(4)
    v_mfma_f32_16x16x32_bf16 v[32:35], v[204:207], v[76:79], v[32:35]
    s_waitcnt lgkmcnt(3)
    v_mfma_f32_16x16x32_bf16 v[32:35], v[208:211], v[80:83], v[32:35]
    s_waitcnt lgkmcnt(2)
    v_mfma_f32_16x16x32_bf16 v[32:35], v[212:215], v[84:87], v[32:35]
    s_waitcnt lgkmcnt(1)
    v_mfma_f32_16x16x32_bf16 v[32:35], v[216:219], v[88:91], v[32:35]
    s_waitcnt lgkmcnt(0)
    v_mfma_f32_16x16x32_bf16 v[32:35], v[220:223], v[92:95], v[32:35]
    s_mov_b32 exec_lo, 0x00ff00ff
    s_mov_b32 exec_hi, 0x00ff00ff
    s_nop 5
    v_bfi_b32 v32, s9, v4, v32
    v_bfi_b32 v33, s9, v5, v33
    v_bfi_b32 v34, s9, v6, v34
    v_bfi_b32 v35, s9, v7, v35
    buffer_store_dwordx4 v[32:35], v18, s[48:51], s10 offen sc0 sc1
    s_mov_b64 exec, -1
    s_waitcnt vmcnt(0)
    s_barrier
    s_branch L_fin

L_pr4:
    s_add_u32 s64, s64, 1
    s_cmp_gt_u32 s64, 200000
    s_cbranch_scc1 L_pd5
    s_sleep 2
    buffer_load_dwordx4 v[52:55], v20, s[48:51], s15 offen sc1
    s_waitcnt vmcnt(0)
    s_branch L_pc3
L_pr28:
    s_add_u32 s64, s64, 1
    s_cmp_gt_u32 s64, 200000
    s_cbranch_scc1 L_pd29
    s_sleep 2
    buffer_load_dwordx4 v[52:55], v46, s[48:51], s65 offen sc1
    s_waitcnt vmcnt(0)
    s_branch L_pc27
L_pr31:
    s_add_u32 s64, s64, 1
    s_cmp_gt_u32 s64, 200000
    s_cbranch_scc1 L_pd32
    s_sleep 1
    buffer_load_dwordx4 v[64:67], v8, s[48:51], s12 offen offset:0 sc1
    buffer_load_dwordx4 v[68:71], v8, s[48:51], s12 offen offset:2048 sc1
    buffer_load_dwordx4 v[72:75], v8, s[48:51], s13 offen offset:0 sc1
    buffer_load_dwordx4 v[76:79], v8, s[48:51], s13 offen offset:2048 sc1
    s_branch L_pc30
L_H:
    s_mov_b32 s52, s16
    s_mov_b32 s53, s17
    s_mov_b32 s54, 0x2000
    s_mov_b32 s55, 0x20000
    s_lshl_b32 s10, s6, 1
    s_add_u32 s10, s10, s7
    s_lshl_b32 s10, s10, 2
    s_add_u32 s10, s10, s5
    s_sub_u32 s10, s10, 4

    v_bfe_u32 v10, v2, 2, 1
    v_lshlrev_b32 v10, 9, v10
    v_lshrrev_b32 v11, 3, v2
    v_lshl_add_u32 v10, v11, 4, v10
    v_and_b32 v11, 3, v2
    v_lshl_add_u32 v10, v11, 2, v10
    v_add_u32 v10, v10, v3
    v_lshlrev_b32 v11, 2, v10
    v_lshlrev_b32 v10, 1, v10
    s_lshr_b32 s14, s10, 4
    s_lshl_b32 s14, s14, 10
    s_and_b32 s12, s10, 15
    s_lshl_b32 s12, s12, 5
    s_add_u32 s12, s12, s14
    s_lshl_b32 s14, s12, 1
    buffer_load_ushort v60, v10, s[52:55], s14 offen
    v_lshlrev_b32 v61, 3, v3
    v_lshrrev_b32 v61, v61, s8
    v_and_b32 v61, 0xff, v61
    s_lshl_b32 s11, s10, 12
    s_add_u32 s11, s11, 1179648
    s_lshl_b32 s12, s12, 2
    s_lshl_b32 s13, s3, 14
    s_add_u32 s13, s13, s12
    s_add_u32 s13, s13, 1507328
    s_cmp_lg_u32 s26, 0
    s_cselect_b32 s100, s13, 805306368
    s_lshl_b32 s101, s3, 7
    s_add_u32 s101, s101, 622592

    s_barrier
    s_waitcnt vmcnt(0)
    v_lshlrev_b32 v60, 16, v60
    s_mov_b32 s64, 0
    buffer_load_dwordx4 v[64:67], v8, s[48:51], s11 offen offset:0 sc1
    buffer_load_dwordx4 v[68:71], v8, s[48:51], s11 offen offset:1024 sc1
    buffer_load_dwordx4 v[72:75], v8, s[48:51], s11 offen offset:2048 sc1
    buffer_load_dwordx4 v[76:79], v8, s[48:51], s11 offen offset:3072 sc1
L_pc33:
    s_waitcnt vmcnt(3)
    v_xor_b32 v64, v4, v64
    v_xor_b32 v65, v5, v65
    v_xor_b32 v66, v6, v66
    v_xor_b32 v67, v7, v67
    v_or3_b32 v31, v64, v65, v66
    v_or_b32 v31, v31, v67
    s_waitcnt vmcnt(2)
    v_xor_b32 v68, v4, v68
    v_xor_b32 v69, v5, v69
    v_xor_b32 v70, v6, v70
    v_xor_b32 v71, v7, v71
    v_or3_b32 v31, v31, v68, v69
    v_or3_b32 v31, v31, v70, v71
    s_waitcnt vmcnt(1)
    v_xor_b32 v72, v4, v72
    v_xor_b32 v73, v5, v73
    v_xor_b32 v74, v6, v74
    v_xor_b32 v75, v7, v75
    v_or3_b32 v31, v31, v72, v73
    v_or3_b32 v31, v31, v74, v75
    s_waitcnt vmcnt(0)
    v_xor_b32 v76, v4, v76
    v_xor_b32 v77, v5, v77
    v_xor_b32 v78, v6, v78
    v_xor_b32 v79, v7, v79
    v_or3_b32 v31, v31, v76, v77
    v_or3_b32 v31, v31, v78, v79
    v_cmp_ne_u32_sdwa vcc, v31, v56 src0_sel:BYTE_0 src1_sel:DWORD
    s_cmp_lg_u64 vcc, 0
    s_cbranch_scc1 L_pr34
L_pd35:
    v_pk_add_f32 v[64:65], v[64:65], v[68:69]
    v_pk_add_f32 v[66:67], v[66:67], v[70:71]
    v_pk_add_f32 v[72:73], v[72:73], v[76:77]
    v_pk_add_f32 v[74:75], v[74:75], v[78:79]
    v_pk_add_f32 v[64:65], v[64:65], v[72:73]
    v_pk_add_f32 v[66:67], v[66:67], v[74:75]
    s_nop 1
    v_permlane32_swap_b32 v64, v66
    v_permlane32_swap_b32 v65, v67
    v_add_f32 v64, v64, v66
    v_add_f32 v65, v65, v67
    s_nop 1
    v_permlane16_swap_b32 v64, v65
    v_add_f32 v64, v64, v65

    v_cvt_pk_bf16_f32 v64, v64, v64
    v_and_b32 v64, 0xffff0000, v64
    v_add_f32 v64, v64, v60
    v_cvt_pk_bf16_f32 v64, v64, v64
    v_bfi_b32 v48, s74, v61, v64
    buffer_store_dword v48, v11, s[48:51], s100 offen
    s_cmp_lg_u32 s26, 0
    s_cbranch_scc1 L_Hd
    v_mov_b32 v49, v48
    v_mov_b32 v50, v48
    s_nop 1
    v_permlane32_swap_b32 v48, v50
    s_nop 0
    v_mov_b32 v51, v50
    v_mov_b32 v49, v48
    s_nop 1
    v_permlane16_swap_b32 v48, v49
    v_permlane16_swap_b32 v50, v51
    s_mov_b64 exec, 0xffff
    s_nop 0
    buffer_store_dwordx4 v[48:51], v11, s[48:51], s13 offen sc0 sc1
    s_mov_b64 exec, -1
L_Hd:

    s_branch L_fin
L_pr34:
    s_add_u32 s64, s64, 1
    s_cmp_gt_u32 s64, 200000
    s_cbranch_scc1 L_pd35
    s_sleep 3
    buffer_load_dwordx4 v[64:67], v8, s[48:51], s11 offen offset:0 sc1
    buffer_load_dwordx4 v[68:71], v8, s[48:51], s11 offen offset:1024 sc1
    buffer_load_dwordx4 v[72:75], v8, s[48:51], s11 offen offset:2048 sc1
    buffer_load_dwordx4 v[76:79], v8, s[48:51], s11 offen offset:3072 sc1
    s_branch L_pc33
L_O:
    s_mov_b32 s56, s34
    s_mov_b32 s57, s35
    s_mov_b32 s58, 0x2000
    s_mov_b32 s59, 0x20000
    s_mov_b32 s10, s86
    s_lshl_b32 s14, s10, 6
    s_lshl_b32 s12, s10, 7
    s_lshl_b32 s11, s3, 14
    s_add_u32 s12, s12, s11
    s_add_u32 s12, s12, 1507328
    s_mul_i32 s13, s10, 3584
    s_add_u32 s13, s13, 2621440
    v_and_b32 v11, 7, v1
    v_lshlrev_b32 v10, 3, v11
    v_lshl_add_u32 v10, v3, 1, v10
    v_lshlrev_b32 v11, 4, v11
    s_mov_b32 s98, 0

L_Ol:
    s_mul_i32 s15, s98, 805306368
    s_or_b32 s101, s14, s15

    s_mov_b32 s64, 0
    buffer_load_dwordx4 v[96:99], v11, s[48:51], s12 offen sc1
L_pc36:
    s_waitcnt vmcnt(0)
    v_xor_b32 v96, v4, v96
    v_xor_b32 v97, v5, v97
    v_xor_b32 v98, v6, v98
    v_xor_b32 v99, v7, v99
    v_or3_b32 v31, v96, v97, v98
    v_or_b32 v31, v31, v99
    v_cmp_ne_u32_sdwa vcc, v31, v56 src0_sel:BYTE_0 src1_sel:DWORD
    s_cmp_lg_u64 vcc, 0
    s_cbranch_scc1 L_pr37
L_pd38:
    v_mov_b32_dpp v96, v97 quad_perm:[0,1,2,3] row_mask:0x2 bank_mask:0xf
    v_mov_b32_dpp v96, v98 quad_perm:[0,1,2,3] row_mask:0x4 bank_mask:0xf
    v_mov_b32_dpp v96, v99 quad_perm:[0,1,2,3] row_mask:0x8 bank_mask:0xf

    s_cmp_eq_u32 s101, 0
    s_cselect_b32 s100, 0, 805306368
    v_mov_b32 v12, s8
    s_mov_b64 exec, 1
    buffer_store_dword v12, v56, s[48:51], s100 offen sc0 sc1
    s_mov_b64 exec, -1

    s_barrier
    s_barrier
    s_mov_b32 s64, 0
    buffer_load_dwordx4 v[64:67], v8, s[48:51], s13 offen offset:0 sc1
    buffer_load_dwordx4 v[68:71], v8, s[48:51], s13 offen offset:1024 sc1
    buffer_load_dwordx4 v[72:75], v8, s[48:51], s13 offen offset:2048 sc1
    v_mov_b32 v76, v4
    v_mov_b32 v77, v5
    v_mov_b32 v78, v6
    v_mov_b32 v79, v7
    s_mov_b32 exec_hi, 0
    buffer_load_dwordx4 v[76:79], v8, s[48:51], s13 offen offset:3072 sc1
    s_mov_b32 exec_hi, -1
L_pc39:
    s_waitcnt vmcnt(3)
    v_xor_b32 v64, v4, v64
    v_xor_b32 v65, v5, v65
    v_xor_b32 v66, v6, v66
    v_xor_b32 v67, v7, v67
    v_or3_b32 v31, v64, v65, v66
    v_or_b32 v31, v31, v67
    s_waitcnt vmcnt(2)
    v_xor_b32 v68, v4, v68
    v_xor_b32 v69, v5, v69
    v_xor_b32 v70, v6, v70
    v_xor_b32 v71, v7, v71
    v_or3_b32 v31, v31, v68, v69
    v_or3_b32 v31, v31, v70, v71
    s_waitcnt vmcnt(1)
    v_xor_b32 v72, v4, v72
    v_xor_b32 v73, v5, v73
    v_xor_b32 v74, v6, v74
    v_xor_b32 v75, v7, v75
    v_or3_b32 v31, v31, v72, v73
    v_or3_b32 v31, v31, v74, v75
    s_waitcnt vmcnt(0)
    v_xor_b32 v76, v4, v76
    v_xor_b32 v77, v5, v77
    v_xor_b32 v78, v6, v78
    v_xor_b32 v79, v7, v79
    v_or3_b32 v31, v31, v76, v77
    v_or3_b32 v31, v31, v78, v79
    v_cmp_ne_u32_sdwa vcc, v31, v56 src0_sel:BYTE_0 src1_sel:DWORD
    s_cmp_lg_u64 vcc, 0
    s_cbranch_scc1 L_pr40
L_pd41:
    v_pk_add_f32 v[64:65], v[64:65], v[68:69]
    v_pk_add_f32 v[66:67], v[66:67], v[70:71]
    v_pk_add_f32 v[72:73], v[72:73], v[76:77]
    v_pk_add_f32 v[74:75], v[74:75], v[78:79]
    v_pk_add_f32 v[64:65], v[64:65], v[72:73]
    v_pk_add_f32 v[66:67], v[66:67], v[74:75]
    s_nop 1
    v_permlane32_swap_b32 v64, v66
    v_permlane32_swap_b32 v65, v67
    v_add_f32 v64, v64, v66
    v_add_f32 v65, v65, v67
    s_nop 1
    v_permlane16_swap_b32 v64, v65
    v_add_f32 v64, v64, v65

    s_nop 1
    v_add_f32_dpp v64, v64, v64 row_ror:8 row_mask:0xf bank_mask:0xf
    s_mov_b32 exec_lo, 0x00ff00ff
    v_cvt_pk_bf16_f32 v64, v64, v64
    s_mov_b32 exec_hi, 0x00ff00ff
    v_and_b32 v64, 0xffff0000, v64
    v_add_f32 v64, v64, v96
    v_cvt_pk_bf16_f32 v100, v64, v64
    buffer_store_short v100, v10, s[56:59], s101 offen
    s_mov_b64 exec, -1
    s_cmp_eq_u32 s98, 0
    s_mov_b32 s98, 0
    s_cbranch_scc0 L_Ol
    s_cmp_lg_u32 s14, 0
    s_cbranch_scc1 L_fin

    s_branch L_fin
L_pr37:
    s_add_u32 s64, s64, 1
    s_cmp_gt_u32 s64, 200000
    s_cbranch_scc1 L_pd38
    s_sleep 6
    buffer_load_dwordx4 v[96:99], v11, s[48:51], s12 offen sc1
    s_branch L_pc36
L_pr40:
    s_add_u32 s64, s64, 1
    s_cmp_gt_u32 s64, 200000
    s_cbranch_scc1 L_pd41
    s_sleep 1
    buffer_load_dwordx4 v[64:67], v8, s[48:51], s13 offen offset:0 sc1
    buffer_load_dwordx4 v[68:71], v8, s[48:51], s13 offen offset:1024 sc1
    buffer_load_dwordx4 v[72:75], v8, s[48:51], s13 offen offset:2048 sc1
    v_mov_b32 v76, v4
    v_mov_b32 v77, v5
    v_mov_b32 v78, v6
    v_mov_b32 v79, v7
    s_mov_b32 exec_hi, 0
    buffer_load_dwordx4 v[76:79], v8, s[48:51], s13 offen offset:3072 sc1
    s_mov_b32 exec_hi, -1
    s_branch L_pc39
L_F:
    s_mov_b32 s84, s3

    s_lshl_b32 s101, s3, 7
    s_add_u32 s101, s101, 622592
    s_mov_b32 s64, 0
    buffer_load_dwordx4 v[40:43], v56, s[48:51], s101 offen sc1
L_pc42:
    s_waitcnt vmcnt(0)
    v_cmp_ne_u32 vcc, s8, v43
    s_cmp_lg_u64 vcc, 0
    s_cbranch_scc1 L_pr43
L_pd44:
    v_readfirstlane_b32 s84, v40
    s_nop 0
    s_and_b32 s84, s84, 7
    s_cmp_eq_u32 s84, 7
    s_cbranch_scc1 L_fin

    s_bfe_u32 s6, s99, 0x20002
    s_lshl_b32 s10, s84, 2
    s_add_u32 s6, s6, s10
    s_and_b32 s7, s99, 3
    s_cmp_ge_u32 s5, 4
    s_cselect_b32 s52, s30, s28
    s_cselect_b32 s53, s31, s29
    s_mov_b32 s54, 1835008
    s_mov_b32 s55, 0x20000
    v_lshrrev_b32 v11, 3, v1
    v_mul_u32_u24 v11, 3584, v11
    v_add_u32 v11, v61, v11
    v_xor_b32 v60, 64, v11
    s_and_b32 s15, s5, 3
    s_lshl_b32 s10, s7, 2
    s_add_u32 s10, s10, s15
    s_mul_i32 s10, s10, 114688
    s_lshl_b32 s11, s6, 7
    s_add_u32 s10, s10, s11

    buffer_load_dwordx4 v11, s[52:55], s10 offen nt lds
    s_add_u32 m0, m0, 1024
    s_add_u32 s10, s10, 28672
    buffer_load_dwordx4 v60, s[52:55], s10 offen nt lds
    s_add_u32 m0, m0, 1024
    s_add_u32 s10, s10, 28672
    buffer_load_dwordx4 v11, s[52:55], s10 offen nt lds
    s_add_u32 m0, m0, 1024
    s_add_u32 s10, s10, 28672
    buffer_load_dwordx4 v60, s[52:55], s10 offen nt lds
    s_mov_b32 s56, s32
    s_mov_b32 s57, s33
    s_mov_b32 s58, 0x1c0000
    s_mov_b32 s59, 0x20000
    v_lshlrev_b32 v12, 10, v3
    v_lshl_add_u32 v12, v2, 4, v12
    s_lshl_b32 s10, s6, 16
    s_lshl_b32 s11, s5, 13
    s_add_u32 s10, s10, s11
    s_lshl_b32 s11, s7, 8
    s_add_u32 s10, s10, s11
    s_mul_i32 s11, s5, 2112
    s_add_u32 m0, s11, 61440
    s_nop 0
    buffer_load_dwordx4 v12, s[56:59], s10 offen nt lds
    s_add_u32 m0, m0, 1056
    s_add_u32 s10, s10, 4096
    buffer_load_dwordx4 v12, s[56:59], s10 offen nt lds
    s_lshr_b32 s14, s5, 2
    s_lshl_b32 s10, s14, 14
    v_add_u32 v23, s10, v23
    v_mul_u32_u24 v12, 2112, v3
    v_lshrrev_b32 v13, 2, v2
    v_lshl_add_u32 v12, v13, 8, v12
    v_and_b32 v13, 3, v2
    v_lshl_add_u32 v12, v13, 3, v12
    s_lshl_b32 s10, s15, 6
    s_add_u32 s10, s10, 61440
    v_add_u32 v12, s10, v12
    s_mul_i32 s10, s5, 272
    v_and_b32 v16, 31, v1
    v_lshl_add_u32 v16, v16, 3, s10
    v_and_b32 v18, 7, v2
    v_mul_u32_u24 v17, 272, v18
    v_lshl_add_u32 v17, v3, 4, v17
    v_mul_u32_u24 v19, 144, v18
    v_lshl_add_u32 v20, v3, 4, v19
    v_lshl_add_u32 v19, v3, 3, v19
    s_lshl_b32 s10, s15, 5
    v_add_u32 v19, s10, v19
    v_lshlrev_b32 v10, 6, v2
    v_lshl_add_u32 v10, v3, 4, v10
    s_and_b32 s76, s6, 3
    s_lshl_b32 s10, s3, 2
    s_add_u32 s76, s76, s10
    s_lshl_b32 s76, s76, 14
    s_lshl_b32 s10, s15, 12
    s_add_u32 s76, s76, s10
    s_add_u32 s76, s76, 655360
    v_xor_b32 v44, 1, v4
    v_xor_b32 v45, 1, v5
    v_xor_b32 v46, 1, v6
    v_xor_b32 v47, 1, v7
    s_lshl_b32 s10, s7, 10
    s_lshl_b32 s11, s14, 9
    s_add_u32 s10, s10, s11
    s_add_u32 s77, s76, s10
    v_mul_u32_u24 v21, 57344, v18
    v_lshrrev_b32 v22, 3, v2
    v_lshl_add_u32 v21, v22, 6, v21
    v_lshl_add_u32 v21, v3, 4, v21
    s_lshl_b32 s80, s7, 2
    s_add_u32 s80, s80, s15
    s_mul_i32 s80, s80, 28
    s_add_u32 s80, s80, s6
    s_lshl_b32 s80, s80, 7
    s_add_u32 s80, s80, 2621440
    v_cmp_lt_u32 s[68:69], 7, v2
    s_lshl_b32 s10, s5, 11
    s_lshl_b32 s14, s3, 14
    s_add_u32 s14, s14, s10
    s_add_u32 s14, s14, 1507328
    s_lshr_b32 s13, s7, 1
    s_lshl_b32 s13, s13, 10
    s_add_u32 s14, s14, s13
    s_xor_b32 s13, s14, 1024
    s_bitcmp1_b32 s7, 0
    s_cselect_b32 s82, 0, -1
    s_cselect_b32 s83, -1, 0

    s_waitcnt vmcnt(0) lgkmcnt(0)
    s_barrier

    ds_read_b64_tr_b16 v[128:129], v23 offset:28672
    ds_read_b64_tr_b16 v[130:131], v23 offset:29184
    ds_read_b64_tr_b16 v[132:133], v23 offset:32768
    ds_read_b64_tr_b16 v[134:135], v23 offset:33280
    ds_read_b64_tr_b16 v[136:137], v23 offset:36864
    ds_read_b64_tr_b16 v[138:139], v23 offset:37376
    ds_read_b64_tr_b16 v[140:141], v23 offset:40960
    ds_read_b64_tr_b16 v[142:143], v23 offset:41472
    s_waitcnt lgkmcnt(4)
    ds_read_b64_tr_b16 v[144:145], v12 offset:0
    ds_read_b64_tr_b16 v[146:147], v12 offset:1056
    ds_read_b64_tr_b16 v[148:149], v12 offset:8448
    ds_read_b64_tr_b16 v[150:151], v12 offset:9504
    ds_read_b64_tr_b16 v[152:153], v12 offset:32
    ds_read_b64_tr_b16 v[154:155], v12 offset:1088
    ds_read_b64_tr_b16 v[156:157], v12 offset:8480
    ds_read_b64_tr_b16 v[158:159], v12 offset:9536
    s_mov_b32 s64, 0
    buffer_load_dwordx4 v[64:67], v8, s[48:51], s14 offen sc1
    buffer_load_dwordx4 v[68:71], v8, s[48:51], s13 offen sc1
L_pc45:
    s_waitcnt vmcnt(1)
    v_xor_b32 v64, v4, v64
    v_xor_b32 v65, v5, v65
    v_xor_b32 v66, v6, v66
    v_xor_b32 v67, v7, v67
    v_or3_b32 v31, v64, v65, v66
    v_or_b32 v31, v31, v67
    s_waitcnt vmcnt(0)
    v_xor_b32 v68, v4, v68
    v_xor_b32 v69, v5, v69
    v_xor_b32 v70, v6, v70
    v_xor_b32 v71, v7, v71
    v_or3_b32 v31, v31, v68, v69
    v_or3_b32 v31, v31, v70, v71
    v_cmp_ne_u32_sdwa vcc, v31, v56 src0_sel:BYTE_0 src1_sel:DWORD
    s_cmp_lg_u64 vcc, 0
    s_cbranch_scc1 L_pr46
L_pd47:
    v_pk_add_f32 v[80:81], v[64:65], v[66:67]
    v_pk_add_f32 v[82:83], v[68:69], v[70:71]
    v_pk_mul_f32 v[84:85], v[64:65], v[64:65]
    v_pk_mul_f32 v[86:87], v[68:69], v[68:69]
    v_pk_add_f32 v[80:81], v[80:81], v[82:83]
    v_pk_fma_f32 v[84:85], v[66:67], v[66:67], v[84:85]
    v_pk_fma_f32 v[86:87], v[70:71], v[70:71], v[86:87]
    v_add_f32 v80, v80, v81
    v_pk_add_f32 v[84:85], v[84:85], v[86:87]
    v_add_f32 v81, v84, v85

    s_nop 0
    v_add_f32_dpp v80, v80, v80 quad_perm:[1,0,3,2] row_mask:0xf bank_mask:0xf
    v_add_f32_dpp v81, v81, v81 quad_perm:[1,0,3,2] row_mask:0xf bank_mask:0xf
    s_nop 0
    v_add_f32_dpp v80, v80, v80 quad_perm:[2,3,0,1] row_mask:0xf bank_mask:0xf
    v_add_f32_dpp v81, v81, v81 quad_perm:[2,3,0,1] row_mask:0xf bank_mask:0xf
    s_nop 0
    v_add_f32_dpp v80, v80, v80 row_half_mirror row_mask:0xf bank_mask:0xf
    v_add_f32_dpp v81, v81, v81 row_half_mirror row_mask:0xf bank_mask:0xf
    s_nop 0
    v_add_f32_dpp v80, v80, v80 row_ror:8 row_mask:0xf bank_mask:0xf
    v_add_f32_dpp v81, v81, v81 row_ror:8 row_mask:0xf bank_mask:0xf
    v_mov_b32 v82, 0x3b000000
    v_add_f32_dpp v80, v80, v80 row_bcast:15 row_mask:0xa bank_mask:0xf
    v_add_f32_dpp v81, v81, v81 row_bcast:15 row_mask:0xa bank_mask:0xf
    s_nop 0
    v_add_f32_dpp v80, v80, v80 row_bcast:31 row_mask:0xc bank_mask:0xf
    v_add_f32_dpp v81, v81, v81 row_bcast:31 row_mask:0xc bank_mask:0xf
    v_readlane_b32 s92, v80, 63
    v_readlane_b32 s93, v81, 63
    s_nop 0
    v_mul_f32 v80, s92, v82
    v_mul_f32 v81, s93, v82
    v_fma_f32 v81, -v80, v80, v81
    v_max_f32 v81, 0, v81
    v_cvt_pk_bf16_f32 v81, v80, v81
    v_lshlrev_b32 v82, 16, v81
    v_and_b32 v81, 0xffff0000, v81
    v_add_f32 v81, 0x3727c5ac, v81

    v_cvt_pk_bf16_f32 v81, v81, v81
    v_and_b32 v81, 0xffff0000, v81
    v_sqrt_f32 v81, v81
    v_pk_add_f32 v[64:65], v[64:65], v[82:83] op_sel_hi:[1,0] neg_lo:[0,1] neg_hi:[0,1]
    v_pk_add_f32 v[66:67], v[66:67], v[82:83] op_sel_hi:[1,0] neg_lo:[0,1] neg_hi:[0,1]
    v_cvt_pk_bf16_f32 v81, v81, v81
    v_and_b32 v81, 0xffff0000, v81
    v_rcp_f32 v84, v81
    v_cvt_pk_bf16_f32 v76, v64, v65
    v_cvt_pk_bf16_f32 v77, v66, v67
    v_lshlrev_b32 v64, 16, v76
    v_and_b32 v65, 0xffff0000, v76
    v_lshlrev_b32 v66, 16, v77
    v_and_b32 v67, 0xffff0000, v77
    v_pk_mul_f32 v[64:65], v[64:65], v[84:85] op_sel_hi:[1,0]
    v_pk_mul_f32 v[66:67], v[66:67], v[84:85] op_sel_hi:[1,0]
    v_cvt_pk_bf16_f32 v76, v64, v65
    v_cvt_pk_bf16_f32 v77, v66, v67
    s_mov_b64 exec, s[82:83]
    ds_write_b64 v16, v[76:77] offset:18432
    s_mov_b64 exec, -1

    s_waitcnt lgkmcnt(0)
    s_barrier
    ds_read_b128 v[160:163], v17 offset:18432
    ds_read_b128 v[164:167], v17 offset:18496
    ds_read_b128 v[168:171], v17 offset:18560
    ds_read_b128 v[172:175], v17 offset:18624
    s_waitcnt lgkmcnt(3)
    v_mfma_f32_16x16x32_bf16 v[32:35], v[128:131], v[160:163], 0
    s_waitcnt lgkmcnt(2)
    v_mfma_f32_16x16x32_bf16 v[32:35], v[132:135], v[164:167], v[32:35]
    s_waitcnt lgkmcnt(1)
    v_mfma_f32_16x16x32_bf16 v[32:35], v[136:139], v[168:171], v[32:35]
    s_waitcnt lgkmcnt(0)
    v_mfma_f32_16x16x32_bf16 v[32:35], v[140:143], v[172:175], v[32:35]
    s_mov_b32 exec_lo, 0x00ff00ff
    s_mov_b32 exec_hi, 0x00ff00ff
    s_cmp_lg_u32 s26, 0
    s_nop 4
    v_bfi_b32 v32, s9, v44, v32
    v_bfi_b32 v33, s9, v45, v33
    v_bfi_b32 v34, s9, v46, v34
    v_bfi_b32 v35, s9, v47, v35
    buffer_store_dwordx4 v[32:35], v10, s[48:51], s77 offen
    s_cbranch_scc1 L_Fs
    buffer_store_dwordx4 v[32:35], v10, s[48:51], s77 offen sc0 sc1
L_Fs:
    s_mov_b64 exec, -1
    s_cmp_ge_u32 s5, 4
    s_barrier
    s_cbranch_scc1 L_Fx

    s_mov_b32 s64, 0
    buffer_load_dwordx4 v[64:67], v10, s[48:51], s76 offen offset:0 sc1
    buffer_load_dwordx4 v[68:71], v10, s[48:51], s76 offen offset:1024 sc1
    buffer_load_dwordx4 v[72:75], v10, s[48:51], s76 offen offset:2048 sc1
    buffer_load_dwordx4 v[76:79], v10, s[48:51], s76 offen offset:3072 sc1
L_pc48:
    s_waitcnt vmcnt(3)
    v_xor_b32 v64, v44, v64
    v_xor_b32 v65, v45, v65
    v_xor_b32 v66, v46, v66
    v_xor_b32 v67, v47, v67
    v_or3_b32 v31, v64, v65, v66
    v_or_b32 v31, v31, v67
    s_waitcnt vmcnt(2)
    v_xor_b32 v68, v44, v68
    v_xor_b32 v69, v45, v69
    v_xor_b32 v70, v46, v70
    v_xor_b32 v71, v47, v71
    v_or3_b32 v31, v31, v68, v69
    v_or3_b32 v31, v31, v70, v71
    s_waitcnt vmcnt(1)
    v_xor_b32 v72, v44, v72
    v_xor_b32 v73, v45, v73
    v_xor_b32 v74, v46, v74
    v_xor_b32 v75, v47, v75
    v_or3_b32 v31, v31, v72, v73
    v_or3_b32 v31, v31, v74, v75
    s_waitcnt vmcnt(0)
    v_xor_b32 v76, v44, v76
    v_xor_b32 v77, v45, v77
    v_xor_b32 v78, v46, v78
    v_xor_b32 v79, v47, v79
    v_or3_b32 v31, v31, v76, v77
    v_or3_b32 v31, v31, v78, v79
    v_cmp_ne_u32_sdwa vcc, v31, v56 src0_sel:BYTE_0 src1_sel:DWORD
    s_cmp_lg_u64 vcc, 0
    s_cbranch_scc1 L_pr49
L_pd50:
    v_pk_add_f32 v[64:65], v[64:65], v[68:69]
    v_pk_add_f32 v[66:67], v[66:67], v[70:71]
    v_pk_add_f32 v[72:73], v[72:73], v[76:77]
    v_pk_add_f32 v[74:75], v[74:75], v[78:79]
    v_pk_add_f32 v[64:65], v[64:65], v[72:73]
    v_pk_add_f32 v[66:67], v[66:67], v[74:75]
    v_cvt_pk_bf16_f32 v68, v64, v65
    v_cvt_pk_bf16_f32 v69, v66, v67
    v_lshlrev_b32 v64, 16, v68
    v_and_b32 v65, 0xffff0000, v68
    v_lshlrev_b32 v66, 16, v69
    v_and_b32 v67, 0xffff0000, v69
    s_nop 0
    v_mul_f32_dpp v68, v64, v64 row_ror:8 row_mask:0xf bank_mask:0xf
    v_mul_f32_dpp v69, v65, v65 row_ror:8 row_mask:0xf bank_mask:0xf
    v_mul_f32_dpp v70, v66, v66 row_ror:8 row_mask:0xf bank_mask:0xf
    v_mul_f32_dpp v71, v67, v67 row_ror:8 row_mask:0xf bank_mask:0xf
    v_cvt_pk_bf16_f32 v64, v68, v69
    v_cvt_pk_bf16_f32 v65, v70, v71
    ds_write_b64 v19, v[64:65] offset:27136
    s_waitcnt lgkmcnt(0)
    s_barrier
    ds_read_b128 v[64:67], v20 offset:27136
    ds_read_b128 v[68:71], v20 offset:27200
    s_waitcnt lgkmcnt(1)
    v_mfma_f32_16x16x32_bf16 v[80:83], v[144:147], v[64:67], 0
    v_mfma_f32_16x16x32_bf16 v[84:87], v[152:155], v[64:67], 0
    s_waitcnt lgkmcnt(0)
    v_mfma_f32_16x16x32_bf16 v[80:83], v[148:151], v[68:71], v[80:83]
    v_mfma_f32_16x16x32_bf16 v[84:87], v[156:159], v[68:71], v[84:87]
    s_nop 7

    v_cndmask_b32 v40, v80, v84, s[68:69]
    v_cndmask_b32 v41, v81, v85, s[68:69]
    v_cndmask_b32 v42, v82, v86, s[68:69]
    v_cndmask_b32 v43, v83, v87, s[68:69]
    v_bfi_b32 v40, s9, v4, v40
    v_bfi_b32 v41, s9, v5, v41
    v_bfi_b32 v42, s9, v6, v42
    v_bfi_b32 v43, s9, v7, v43
    buffer_store_dwordx4 v[40:43], v21, s[48:51], s80 offen sc0 sc1
    s_waitcnt vmcnt(0)
    s_barrier
    s_branch L_fin

L_pr43:
    s_add_u32 s64, s64, 1
    s_cmp_gt_u32 s64, 200000
    s_cbranch_scc1 L_pd44
    s_sleep 4
    buffer_load_dwordx4 v[40:43], v56, s[48:51], s101 offen sc1
    s_branch L_pc42
L_pr46:
    s_add_u32 s64, s64, 1
    s_cmp_gt_u32 s64, 200000
    s_cbranch_scc1 L_pd47
    s_sleep 1
    buffer_load_dwordx4 v[64:67], v8, s[48:51], s14 offen sc1
    buffer_load_dwordx4 v[68:71], v8, s[48:51], s13 offen sc1
    s_branch L_pc45
L_pr49:
    s_add_u32 s64, s64, 1
    s_cmp_gt_u32 s64, 200000
    s_cbranch_scc1 L_pd50
    s_sleep 1
    buffer_load_dwordx4 v[64:67], v10, s[48:51], s76 offen offset:0 sc1
    buffer_load_dwordx4 v[68:71], v10, s[48:51], s76 offen offset:1024 sc1
    buffer_load_dwordx4 v[72:75], v10, s[48:51], s76 offen offset:2048 sc1
    buffer_load_dwordx4 v[76:79], v10, s[48:51], s76 offen offset:3072 sc1
    s_branch L_pc48
L_Fx:
    s_lshl_b32 s86, s84, 4
    s_add_u32 s86, s86, s99
    s_sub_u32 s86, s86, 16
    s_cmp_eq_u32 s5, 4
    s_cbranch_scc1 L_O
    s_add_u32 s86, s86, 112
    s_cmp_lg_u32 s5, 5
    s_cbranch_scc1 L_Fz
    s_cmp_lt_u32 s86, 128
    s_cbranch_scc1 L_O
L_Fz:
    s_barrier
L_fin:

L_end:
    s_endpgm
    .p2align 4
L_codeend:

.section .rodata,"a"
.p2align 6
.amdhsa_kernel sequential_preLN__sliding_block_cached__glu_gated_bilinear__decode_kernel
  .amdhsa_next_free_vgpr 256
  .amdhsa_next_free_sgpr 102
  .amdhsa_accum_offset 256
  .amdhsa_group_segment_fixed_size 0
  .amdhsa_kernarg_size 96
  .amdhsa_user_sgpr_count 2
  .amdhsa_user_sgpr_kernarg_segment_ptr 1
  .amdhsa_system_sgpr_workgroup_id_x 1
  .amdhsa_float_denorm_mode_32 3
.end_amdhsa_kernel
```
